```python
import torch

def _softmax(x, axis=-1):
    return torch.softmax(x, dim=axis)
def _gelu(x):
    return torch.nn.functional.gelu(x, approximate="tanh")
def _silu(x):
    return torch.nn.functional.silu(x)
def _sigmoid(x):
    return torch.sigmoid(x)
def _layernorm(x, axis=-1, eps=1e-5):
    m = x.mean(dim=axis, keepdim=True)
    v = x.var(dim=axis, keepdim=True, unbiased=False)
    return (x - m) / torch.sqrt(v + eps)
def _scatter_add(tgt, idx, src, axis=0):
    return tgt.clone().index_add_(axis, idx, src)
def _segment_sum(src, seg, n):
    out = torch.zeros((n,) + src.shape[1:], dtype=src.dtype)
    return out.index_add_(0, seg, src)
def _pad(x, pw):
    flat = tuple(v for pair in reversed(pw) for v in pair)
    return torch.nn.functional.pad(x, flat)

kernel_name = 'sequential_preLN__sliding_block_cached__glu_gated_swiglu__decode'

def setup_inputs():

    _w = (lambda a: (lambda t: t.to(torch.bfloat16) if t.is_floating_point() else t)(torch.as_tensor(a)))
    def _A_setup():
        B, Sq, D = 1, 1, 512
        Hq, Hkv, Sk, Dh = 32, 8, 65536, 128
        assert Hq % Hkv == 0, (Hq, Hkv)
        return {
            "x": _w((lambda *s: torch.randn(*s, dtype=torch.bfloat16) * 0.05)(B, Sq, D)),
            "k_cache": _w((lambda *s: torch.randn(*s, dtype=torch.bfloat16) * 1.6)(B, Hkv, Sk, Dh)),
            "v_cache": _w((lambda *s: torch.randn(*s, dtype=torch.bfloat16) * 0.8)(B, Hkv, Sk, Dh)),
            "wq": _w((lambda *s: torch.randn(*s, dtype=torch.bfloat16) * 1.6)(D, Hq * Dh) * (D ** -0.5)),
            "wo": _w((lambda *s: torch.randn(*s, dtype=torch.bfloat16) * 0.8)(Hq * Dh, D) * ((Hq * Dh) ** -0.5)),
        }
    _A_in = _A_setup()

    def _B_setup():
        B, S, D, F = 1, 1, 512, 1792
        return {
            "x": _w((lambda *s: torch.randn(*s, dtype=torch.bfloat16) * 0.05)(B, S, D)),
            "w1": _w((lambda *s: torch.randn(*s, dtype=torch.bfloat16) * 0.4)(D, F) * (2.0 / D) ** 0.5),
            "w3": _w((lambda *s: torch.randn(*s, dtype=torch.bfloat16) * 0.4)(D, F) * (2.0 / D) ** 0.5),
            "w2": _w((lambda *s: torch.randn(*s, dtype=torch.bfloat16) * 0.4)(F, D) * (2.0 / F) ** 0.5),
        }
    _B_in = _B_setup()

    return {
        "A_x": _A_in["x"],
        "A_k_cache": _A_in["k_cache"],
        "A_v_cache": _A_in["v_cache"],
        "A_wq": _A_in["wq"],
        "A_wo": _A_in["wo"],
        "B_x": _B_in["x"],
        "B_w1": _B_in["w1"],
        "B_w3": _B_in["w3"],
        "B_w2": _B_in["w2"],
    }

def reference(A_x, A_k_cache, A_v_cache, A_wq, A_wo, B_x, B_w1, B_w3, B_w2):
    def _A_ref(x, k_cache, v_cache, wq, wo):
        B, Sq, D = x.shape
        Hq, Dh = 32, 128
        Hkv, Sk = k_cache.shape[1], k_cache.shape[2]
        W = min(4096, max(256, Sk // 4))
        rep = Hq // Hkv
        q = (lambda x, *d: x.permute(*d))((x @ wq).reshape(B, Sq, Hq, Dh), 0, 2, 1, 3)
        k = (lambda x, n, axis: torch.repeat_interleave(x, n, dim=axis))(k_cache[:, :, Sk - W:, :], rep, axis=1)
        v = (lambda x, n, axis: torch.repeat_interleave(x, n, dim=axis))(v_cache[:, :, Sk - W:, :], rep, axis=1)
        scores = torch.einsum("bhqd,bhkd->bhqk", q, k) * (Dh ** -0.5)
        p = _softmax(scores, axis=-1)
        o = torch.einsum("bhqk,bhkd->bhqd", p, v)
        return (lambda x, *d: x.permute(*d))(o, 0, 2, 1, 3).reshape(B, Sq, Hq * Dh) @ wo

    def _B_ref(x, w1, w3, w2):
        gate = torch.einsum("bsd,df->bsf", x, w1)
        up = torch.einsum("bsd,df->bsf", x, w3)
        h = _silu(gate) * up
        out = torch.einsum("bsf,fd->bsd", h, w2)
        return out

    x = A_x
    h = x + _A_ref(_layernorm(x, axis=-1), A_k_cache, A_v_cache, A_wq, A_wo)
    h2 = h + _B_ref(_layernorm(h, axis=-1), B_w1, B_w3, B_w2)
    return h2
```

```asm
; @launch grid=(256,1,1) block=(320,1,1) lds=138240
.amdgcn_target "amdgcn-amd-amdhsa--gfx950"
.text
.globl sequential_preLN__sliding_block_cached__glu_gated_swiglu__decode_kernel
.p2align 8
.type sequential_preLN__sliding_block_cached__glu_gated_swiglu__decode_kernel,@function
sequential_preLN__sliding_block_cached__glu_gated_swiglu__decode_kernel:
    s_cmp_ge_u32 s2, 256
    s_cbranch_scc1 L_end
    s_load_dwordx16 s[16:31], s[0:1], 0
    s_load_dwordx8 s[32:39], s[0:1], 64
    s_getpc_b64 s[14:15]
    v_lshlrev_b32 v7, 7, v0
    v_min_u32 v7, 17280, v7
    global_load_dword v15, v7, s[14:15]
    v_lshrrev_b32 v7, 6, v0
    v_and_b32 v1, 63, v0
    v_readfirstlane_b32 s3, v7
    s_and_b32 s4, s2, 7
    s_lshr_b32 s5, s2, 3
    v_and_b32 v2, 15, v1
    v_lshrrev_b32 v3, 4, v1
    v_lshlrev_b32 v4, 4, v1
    v_mov_b32 v5, 137728
    v_mov_b32 v6, 1
    v_lshlrev_b32 v7, 2, v1
    v_add_u32 v7, 137600, v7
    v_mov_b32 v8, 0
    v_mov_b32 v9, 0x3f803f80
    ds_write_b32 v7, v8 offset:128
    s_mov_b32 exec_hi, 0
    ds_write_b32 v7, v9
    s_mov_b64 exec, -1
    s_cmp_eq_u32 s3, 4
    s_cbranch_scc1 L_loader
    s_waitcnt lgkmcnt(0)
    global_load_dwordx4 v[24:27], v4, s[16:17]
    s_load_dword s56, s[38:39], 0
    s_barrier
    s_branch L_compute
L_loader:
    v_and_b32 v7, 7, v1
    v_lshlrev_b32 v8, 1, v3
    v_xor_b32 v7, v7, v8
    v_lshlrev_b32 v7, 4, v7
    v_bfe_u32 v9, v1, 3, 2
    v_lshrrev_b32 v10, 5, v1
    v_lshl_add_u32 v9, v10, 3, v9
    v_lshl_add_u32 v110, v9, 13, v7
    s_lshr_b32 s7, s5, 3
    s_and_b32 s8, s5, 7
    s_lshl_b32 s9, s7, 20
    s_lshl_b32 s10, s4, 10
    s_add_u32 s9, s9, s10
    s_lshl_b32 s10, s8, 7
    s_add_u32 s9, s9, s10
    s_waitcnt lgkmcnt(0)
    s_add_u32 s52, s22, s9
    s_addc_u32 s53, s23, 0
    s_mov_b32 m0, 65536
s_nop 0
    global_load_lds_dwordx4 v110, s[52:53] nt
    s_mov_b32 m0, 66560
    s_add_u32 s52, s52, 131072
    s_addc_u32 s53, s53, 0
    global_load_lds_dwordx4 v110, s[52:53] nt
    s_mov_b32 m0, 67584
    s_sub_u32 s52, s52, 98304
    s_subb_u32 s53, s53, 0
    global_load_lds_dwordx4 v110, s[52:53] nt
    s_mov_b32 m0, 68608
    s_add_u32 s52, s52, 131072
    s_addc_u32 s53, s53, 0
    global_load_lds_dwordx4 v110, s[52:53] nt
    s_mov_b32 m0, 69632
    s_add_u32 s52, s52, 98304
    s_addc_u32 s53, s53, 0
    global_load_lds_dwordx4 v110, s[52:53] nt
    s_mov_b32 m0, 70656
    s_add_u32 s52, s52, 131072
    s_addc_u32 s53, s53, 0
    global_load_lds_dwordx4 v110, s[52:53] nt
    s_mov_b32 m0, 71680
    s_sub_u32 s52, s52, 98304
    s_subb_u32 s53, s53, 0
    global_load_lds_dwordx4 v110, s[52:53] nt
    s_mov_b32 m0, 72704
    s_add_u32 s52, s52, 131072
    s_addc_u32 s53, s53, 0
    global_load_lds_dwordx4 v110, s[52:53] nt
    s_mov_b32 m0, 73728
    s_add_u32 s52, s52, 98304
    s_addc_u32 s53, s53, 0
    global_load_lds_dwordx4 v110, s[52:53] nt
    s_mov_b32 m0, 74752
    s_add_u32 s52, s52, 131072
    s_addc_u32 s53, s53, 0
    global_load_lds_dwordx4 v110, s[52:53] nt
    s_mov_b32 m0, 75776
    s_sub_u32 s52, s52, 98304
    s_subb_u32 s53, s53, 0
    global_load_lds_dwordx4 v110, s[52:53] nt
    s_mov_b32 m0, 76800
    s_add_u32 s52, s52, 131072
    s_addc_u32 s53, s53, 0
    global_load_lds_dwordx4 v110, s[52:53] nt
    s_mov_b32 m0, 77824
    s_add_u32 s52, s52, 98304
    s_addc_u32 s53, s53, 0
    global_load_lds_dwordx4 v110, s[52:53] nt
    s_mov_b32 m0, 78848
    s_add_u32 s52, s52, 131072
    s_addc_u32 s53, s53, 0
    global_load_lds_dwordx4 v110, s[52:53] nt
    s_mov_b32 m0, 79872
    s_sub_u32 s52, s52, 98304
    s_subb_u32 s53, s53, 0
    global_load_lds_dwordx4 v110, s[52:53] nt
    s_mov_b32 m0, 80896
    s_add_u32 s52, s52, 131072
    s_addc_u32 s53, s53, 0
    global_load_lds_dwordx4 v110, s[52:53] nt
    s_barrier
    v_lshrrev_b32 v8, 3, v1
    v_lshl_add_u32 v111, v8, 10, v7
    v_mul_u32_u24 v112, 3584, v8
    v_add_u32 v112, v112, v7
    v_xor_b32 v7, v2, v3
    v_lshlrev_b32 v8, 8, v3
    v_lshl_add_u32 v104, v7, 4, v8
    v_xor_b32 v105, 64, v104
    v_xor_b32 v106, 128, v104
    v_xor_b32 v107, 192, v104
    v_lshlrev_b32 v7, 1, v3
    v_xor_b32 v7, v2, v7
    v_lshl_add_u32 v108, v7, 4, v8
    v_xor_b32 v109, 128, v108
    v_lshlrev_b32 v8, 10, v3
    v_lshl_add_u32 v113, v7, 4, v8
    v_xor_b32 v114, 128, v113
    v_add_u32 v115, 63488, v108
    v_add_u32 v127, 95232, v109
    v_add_u32 v109, 31744, v109
    v_add_u32 v105, 31744, v105
    v_add_u32 v106, 63488, v106
    v_add_u32 v107, 95232, v107
    s_mul_i32 s12, s2, 0
    s_lshl_b32 s6, s4, 24
    s_lshl_b32 s9, s5, 10
    s_add_u32 s6, s6, s9
    s_add_u32 s6, s6, 15728640
    s_add_u32 s40, s18, s6
    s_addc_u32 s41, s19, 0
    s_add_u32 s42, s20, s6
    s_addc_u32 s43, s21, 0
    s_lshl_b32 s6, s4, 2
    s_add_u32 s6, s6, s7
    s_lshl_b32 s9, s6, 17
    s_lshl_b32 s10, s8, 7
    s_add_u32 s9, s9, s10
    s_add_u32 s44, s24, s9
    s_addc_u32 s45, s25, 0
    s_mul_i32 s9, s8, 229376
    s_lshl_b32 s10, s6, 7
    s_add_u32 s9, s9, s10
    s_add_u32 s46, s28, s9
    s_addc_u32 s47, s29, 0
    s_add_u32 s48, s30, s9
    s_addc_u32 s49, s31, 0
    s_lshl_b32 s9, s4, 18
    s_lshl_b32 s10, s8, 15
    s_add_u32 s9, s9, s10
    s_lshl_b32 s10, s7, 8
    s_add_u32 s9, s9, s10
    s_add_u32 s50, s32, s9
    s_addc_u32 s51, s33, 0
    s_mov_b32 s11, 0
    s_cmp_eq_u32 s4, 7
    s_cbranch_scc1 L_loader7
    s_waitcnt vmcnt(15)
    s_add_u32 s13, s12, 0
    s_and_b32 s13, s13, 7
    s_lshl_b32 s6, s13, 12
    s_add_u32 m0, s6, 0
    s_lshl_b32 s6, s13, 17
    s_add_u32 s60, s40, s6
    s_addc_u32 s61, s41, 0
    global_load_lds_dwordx4 v104, s[60:61] offset:0 nt
    s_waitcnt vmcnt(15)
    global_load_lds_dwordx4 v105, s[60:61] offset:1024 nt
    s_waitcnt vmcnt(15)
    global_load_lds_dwordx4 v106, s[60:61] offset:2048 nt
    s_waitcnt vmcnt(15)
    global_load_lds_dwordx4 v107, s[60:61] offset:3072 nt
    s_waitcnt vmcnt(15)
    s_add_u32 s13, s12, 1
    s_and_b32 s13, s13, 7
    s_lshl_b32 s6, s13, 12
    s_add_u32 m0, s6, 0
    s_lshl_b32 s6, s13, 17
    s_add_u32 s60, s40, s6
    s_addc_u32 s61, s41, 0
    global_load_lds_dwordx4 v104, s[60:61] offset:0 nt
    s_waitcnt vmcnt(15)
    global_load_lds_dwordx4 v105, s[60:61] offset:1024 nt
    s_waitcnt vmcnt(15)
    global_load_lds_dwordx4 v106, s[60:61] offset:2048 nt
    s_waitcnt vmcnt(15)
    global_load_lds_dwordx4 v107, s[60:61] offset:3072 nt
    s_waitcnt vmcnt(15)
    s_add_u32 s13, s12, 2
    s_and_b32 s13, s13, 7
    s_lshl_b32 s6, s13, 12
    s_add_u32 m0, s6, 0
    s_lshl_b32 s6, s13, 17
    s_add_u32 s60, s40, s6
    s_addc_u32 s61, s41, 0
    global_load_lds_dwordx4 v104, s[60:61] offset:0 nt
    s_waitcnt vmcnt(15)
    global_load_lds_dwordx4 v105, s[60:61] offset:1024 nt
    s_waitcnt vmcnt(15)
    global_load_lds_dwordx4 v106, s[60:61] offset:2048 nt
    s_waitcnt vmcnt(15)
    global_load_lds_dwordx4 v107, s[60:61] offset:3072 nt
    s_waitcnt vmcnt(15)
    s_add_u32 s13, s12, 3
    s_and_b32 s13, s13, 7
    s_lshl_b32 s6, s13, 12
    s_add_u32 m0, s6, 0
    s_lshl_b32 s6, s13, 17
    s_add_u32 s60, s40, s6
    s_addc_u32 s61, s41, 0
    global_load_lds_dwordx4 v104, s[60:61] offset:0 nt
    s_waitcnt vmcnt(15)
    global_load_lds_dwordx4 v105, s[60:61] offset:1024 nt
    s_waitcnt vmcnt(15)
    global_load_lds_dwordx4 v106, s[60:61] offset:2048 nt
    s_waitcnt vmcnt(15)
    s_mov_b64 exec, 1
    ds_add_u32 v5, v6 offset:0
    s_mov_b64 exec, -1
    global_load_lds_dwordx4 v107, s[60:61] offset:3072 nt
    s_waitcnt vmcnt(15)
    s_add_u32 s13, s12, 4
    s_and_b32 s13, s13, 7
    s_lshl_b32 s6, s13, 12
    s_add_u32 m0, s6, 0
    s_lshl_b32 s6, s13, 17
    s_add_u32 s60, s40, s6
    s_addc_u32 s61, s41, 0
    global_load_lds_dwordx4 v104, s[60:61] offset:0 nt
    s_waitcnt vmcnt(15)
    global_load_lds_dwordx4 v105, s[60:61] offset:1024 nt
    s_waitcnt vmcnt(15)
    global_load_lds_dwordx4 v106, s[60:61] offset:2048 nt
    s_waitcnt vmcnt(15)
    global_load_lds_dwordx4 v107, s[60:61] offset:3072 nt
    s_waitcnt vmcnt(15)
    s_add_u32 s13, s12, 5
    s_and_b32 s13, s13, 7
    s_lshl_b32 s6, s13, 12
    s_add_u32 m0, s6, 0
    s_lshl_b32 s6, s13, 17
    s_add_u32 s60, s40, s6
    s_addc_u32 s61, s41, 0
    global_load_lds_dwordx4 v104, s[60:61] offset:0 nt
    s_waitcnt vmcnt(15)
    global_load_lds_dwordx4 v105, s[60:61] offset:1024 nt
    s_waitcnt vmcnt(15)
    global_load_lds_dwordx4 v106, s[60:61] offset:2048 nt
    s_waitcnt vmcnt(15)
    global_load_lds_dwordx4 v107, s[60:61] offset:3072 nt
    s_waitcnt vmcnt(15)
    s_add_u32 s13, s12, 6
    s_and_b32 s13, s13, 7
    s_lshl_b32 s6, s13, 12
    s_add_u32 m0, s6, 0
    s_lshl_b32 s6, s13, 17
    s_add_u32 s60, s40, s6
    s_addc_u32 s61, s41, 0
    global_load_lds_dwordx4 v104, s[60:61] offset:0 nt
    s_waitcnt vmcnt(15)
    global_load_lds_dwordx4 v105, s[60:61] offset:1024 nt
    s_waitcnt vmcnt(15)
    global_load_lds_dwordx4 v106, s[60:61] offset:2048 nt
    s_waitcnt vmcnt(15)
    global_load_lds_dwordx4 v107, s[60:61] offset:3072 nt
    s_waitcnt vmcnt(15)
    s_add_u32 s13, s12, 7
    s_and_b32 s13, s13, 7
    s_lshl_b32 s6, s13, 12
    s_add_u32 m0, s6, 0
    s_lshl_b32 s6, s13, 17
    s_add_u32 s60, s40, s6
    s_addc_u32 s61, s41, 0
    global_load_lds_dwordx4 v104, s[60:61] offset:0 nt
    s_waitcnt vmcnt(15)
    global_load_lds_dwordx4 v105, s[60:61] offset:1024 nt
    s_waitcnt vmcnt(15)
    global_load_lds_dwordx4 v106, s[60:61] offset:2048 nt
    s_waitcnt vmcnt(15)
    global_load_lds_dwordx4 v107, s[60:61] offset:3072 nt
    s_waitcnt vmcnt(31)
    s_add_u32 s13, s12, 0
    s_and_b32 s13, s13, 7
    s_lshl_b32 s6, s13, 12
    s_add_u32 m0, s6, 32768
    s_lshl_b32 s6, s13, 17
    s_add_u32 s60, s42, s6
    s_addc_u32 s61, s43, 0
    global_load_lds_dwordx4 v108, s[60:61] offset:0 nt
    s_waitcnt vmcnt(31)
    global_load_lds_dwordx4 v109, s[60:61] offset:1024 nt
    s_waitcnt vmcnt(31)
    global_load_lds_dwordx4 v115, s[60:61] offset:2048 nt
    s_waitcnt vmcnt(31)
    global_load_lds_dwordx4 v127, s[60:61] offset:3072 nt
    s_waitcnt vmcnt(31)
    s_add_u32 s13, s12, 1
    s_and_b32 s13, s13, 7
    s_lshl_b32 s6, s13, 12
    s_add_u32 m0, s6, 32768
    s_lshl_b32 s6, s13, 17
    s_add_u32 s60, s42, s6
    s_addc_u32 s61, s43, 0
    global_load_lds_dwordx4 v108, s[60:61] offset:0 nt
    s_waitcnt vmcnt(31)
    global_load_lds_dwordx4 v109, s[60:61] offset:1024 nt
    s_waitcnt vmcnt(31)
    global_load_lds_dwordx4 v115, s[60:61] offset:2048 nt
    s_waitcnt vmcnt(31)
    global_load_lds_dwordx4 v127, s[60:61] offset:3072 nt
    s_waitcnt vmcnt(31)
    s_add_u32 s13, s12, 2
    s_and_b32 s13, s13, 7
    s_lshl_b32 s6, s13, 12
    s_add_u32 m0, s6, 32768
    s_lshl_b32 s6, s13, 17
    s_add_u32 s60, s42, s6
    s_addc_u32 s61, s43, 0
    global_load_lds_dwordx4 v108, s[60:61] offset:0 nt
    s_waitcnt vmcnt(31)
    global_load_lds_dwordx4 v109, s[60:61] offset:1024 nt
    s_waitcnt vmcnt(31)
    global_load_lds_dwordx4 v115, s[60:61] offset:2048 nt
    s_waitcnt vmcnt(31)
    global_load_lds_dwordx4 v127, s[60:61] offset:3072 nt
    s_waitcnt vmcnt(31)
    s_add_u32 s13, s12, 3
    s_and_b32 s13, s13, 7
    s_lshl_b32 s6, s13, 12
    s_add_u32 m0, s6, 32768
    s_lshl_b32 s6, s13, 17
    s_add_u32 s60, s42, s6
    s_addc_u32 s61, s43, 0
    global_load_lds_dwordx4 v108, s[60:61] offset:0 nt
    s_waitcnt vmcnt(31)
    global_load_lds_dwordx4 v109, s[60:61] offset:1024 nt
    s_waitcnt vmcnt(31)
    global_load_lds_dwordx4 v115, s[60:61] offset:2048 nt
    s_waitcnt vmcnt(31)
    global_load_lds_dwordx4 v127, s[60:61] offset:3072 nt
    s_waitcnt vmcnt(31)
    s_add_u32 s13, s12, 4
    s_and_b32 s13, s13, 7
    s_lshl_b32 s6, s13, 12
    s_add_u32 m0, s6, 32768
    s_lshl_b32 s6, s13, 17
    s_add_u32 s60, s42, s6
    s_addc_u32 s61, s43, 0
    global_load_lds_dwordx4 v108, s[60:61] offset:0 nt
    s_waitcnt vmcnt(31)
    global_load_lds_dwordx4 v109, s[60:61] offset:1024 nt
    s_waitcnt vmcnt(31)
    global_load_lds_dwordx4 v115, s[60:61] offset:2048 nt
    s_waitcnt vmcnt(31)
    global_load_lds_dwordx4 v127, s[60:61] offset:3072 nt
    s_waitcnt vmcnt(31)
    s_add_u32 s13, s12, 5
    s_and_b32 s13, s13, 7
    s_lshl_b32 s6, s13, 12
    s_add_u32 m0, s6, 32768
    s_lshl_b32 s6, s13, 17
    s_add_u32 s60, s42, s6
    s_addc_u32 s61, s43, 0
    global_load_lds_dwordx4 v108, s[60:61] offset:0 nt
    s_waitcnt vmcnt(31)
    global_load_lds_dwordx4 v109, s[60:61] offset:1024 nt
    s_waitcnt vmcnt(31)
    global_load_lds_dwordx4 v115, s[60:61] offset:2048 nt
    s_waitcnt vmcnt(31)
    global_load_lds_dwordx4 v127, s[60:61] offset:3072 nt
    s_waitcnt vmcnt(31)
    s_add_u32 s13, s12, 6
    s_and_b32 s13, s13, 7
    s_lshl_b32 s6, s13, 12
    s_add_u32 m0, s6, 32768
    s_lshl_b32 s6, s13, 17
    s_add_u32 s60, s42, s6
    s_addc_u32 s61, s43, 0
    global_load_lds_dwordx4 v108, s[60:61] offset:0 nt
    s_waitcnt vmcnt(31)
    global_load_lds_dwordx4 v109, s[60:61] offset:1024 nt
    s_waitcnt vmcnt(31)
    global_load_lds_dwordx4 v115, s[60:61] offset:2048 nt
    s_waitcnt vmcnt(31)
    global_load_lds_dwordx4 v127, s[60:61] offset:3072 nt
    s_waitcnt vmcnt(31)
    s_add_u32 s13, s12, 7
    s_and_b32 s13, s13, 7
    s_lshl_b32 s6, s13, 12
    s_add_u32 m0, s6, 32768
    s_lshl_b32 s6, s13, 17
    s_add_u32 s60, s42, s6
    s_addc_u32 s61, s43, 0
    global_load_lds_dwordx4 v108, s[60:61] offset:0 nt
    s_waitcnt vmcnt(31)
    global_load_lds_dwordx4 v109, s[60:61] offset:1024 nt
    s_waitcnt vmcnt(31)
    global_load_lds_dwordx4 v115, s[60:61] offset:2048 nt
    s_waitcnt vmcnt(31)
    s_mov_b64 exec, 1
    ds_add_u32 v5, v6 offset:24
    s_mov_b64 exec, -1
    global_load_lds_dwordx4 v127, s[60:61] offset:3072 nt
    s_waitcnt vmcnt(31)
    s_mov_b32 m0, 81920
s_nop 0
    global_load_lds_dwordx4 v111, s[44:45] nt
    s_waitcnt vmcnt(31)
    s_mov_b32 m0, 82944
    s_add_u32 s44, s44, 8192
    s_addc_u32 s45, s45, 0
    global_load_lds_dwordx4 v111, s[44:45] nt
    s_waitcnt vmcnt(31)
    s_mov_b32 m0, 83968
    s_add_u32 s44, s44, 8192
    s_addc_u32 s45, s45, 0
    global_load_lds_dwordx4 v111, s[44:45] nt
    s_waitcnt vmcnt(31)
    s_mov_b32 m0, 84992
    s_add_u32 s44, s44, 8192
    s_addc_u32 s45, s45, 0
    global_load_lds_dwordx4 v111, s[44:45] nt
    s_waitcnt vmcnt(31)
    s_mov_b32 m0, 86016
    s_add_u32 s44, s44, 8192
    s_addc_u32 s45, s45, 0
    global_load_lds_dwordx4 v111, s[44:45] nt
    s_waitcnt vmcnt(31)
    s_mov_b32 m0, 87040
    s_add_u32 s44, s44, 8192
    s_addc_u32 s45, s45, 0
    global_load_lds_dwordx4 v111, s[44:45] nt
    s_waitcnt vmcnt(31)
    s_mov_b32 m0, 88064
    s_add_u32 s44, s44, 8192
    s_addc_u32 s45, s45, 0
    global_load_lds_dwordx4 v111, s[44:45] nt
    s_waitcnt vmcnt(31)
    s_mov_b32 m0, 89088
    s_add_u32 s44, s44, 8192
    s_addc_u32 s45, s45, 0
    global_load_lds_dwordx4 v111, s[44:45] nt
    s_waitcnt vmcnt(31)
    s_mov_b32 m0, 90112
    s_add_u32 s44, s44, 8192
    s_addc_u32 s45, s45, 0
    global_load_lds_dwordx4 v111, s[44:45] nt
    s_waitcnt vmcnt(31)
    s_mov_b32 m0, 91136
    s_add_u32 s44, s44, 8192
    s_addc_u32 s45, s45, 0
    global_load_lds_dwordx4 v111, s[44:45] nt
    s_waitcnt vmcnt(31)
    s_mov_b32 m0, 92160
    s_add_u32 s44, s44, 8192
    s_addc_u32 s45, s45, 0
    global_load_lds_dwordx4 v111, s[44:45] nt
    s_waitcnt vmcnt(31)
    s_mov_b32 m0, 93184
    s_add_u32 s44, s44, 8192
    s_addc_u32 s45, s45, 0
    global_load_lds_dwordx4 v111, s[44:45] nt
    s_waitcnt vmcnt(31)
    s_mov_b32 m0, 94208
    s_add_u32 s44, s44, 8192
    s_addc_u32 s45, s45, 0
    global_load_lds_dwordx4 v111, s[44:45] nt
    s_waitcnt vmcnt(31)
    s_mov_b32 m0, 95232
    s_add_u32 s44, s44, 8192
    s_addc_u32 s45, s45, 0
    global_load_lds_dwordx4 v111, s[44:45] nt
    s_waitcnt vmcnt(31)
    s_mov_b32 m0, 96256
    s_add_u32 s44, s44, 8192
    s_addc_u32 s45, s45, 0
    global_load_lds_dwordx4 v111, s[44:45] nt
    s_waitcnt vmcnt(31)
    s_mov_b32 m0, 97280
    s_add_u32 s44, s44, 8192
    s_addc_u32 s45, s45, 0
    global_load_lds_dwordx4 v111, s[44:45] nt
    s_waitcnt vmcnt(16)
    s_mov_b64 exec, 1
    ds_add_u32 v5, v6 offset:28
    s_mov_b64 exec, -1
    s_waitcnt vmcnt(0)
    s_mov_b64 exec, 1
    ds_add_u32 v5, v6 offset:32
    s_mov_b64 exec, -1
    ds_read_b32 v11, v5 offset:44
    s_waitcnt lgkmcnt(0)
    v_cmp_le_u32 vcc, 4, v11
    s_cbranch_vccnz L_lwok_33
    s_mov_b32 s63, 16777216
L_lw_32:
    s_sleep 1
    ds_read_b32 v11, v5 offset:44
    s_sub_u32 s63, s63, 1
    s_cbranch_scc1 L_end
    s_waitcnt lgkmcnt(0)
    v_cmp_le_u32 vcc, 4, v11
    s_cbranch_vccz L_lw_32
L_lwok_33:
    s_waitcnt vmcnt(39)
    s_mov_b32 m0, 98304
s_nop 0
    global_load_lds_dwordx4 v112, s[46:47] nt
    s_waitcnt vmcnt(39)
    s_mov_b32 m0, 99328
    s_add_u32 s46, s46, 28672
    s_addc_u32 s47, s47, 0
    global_load_lds_dwordx4 v112, s[46:47] nt
    s_waitcnt vmcnt(39)
    s_mov_b32 m0, 100352
    s_add_u32 s46, s46, 28672
    s_addc_u32 s47, s47, 0
    global_load_lds_dwordx4 v112, s[46:47] nt
    s_waitcnt vmcnt(39)
    s_mov_b32 m0, 101376
    s_add_u32 s46, s46, 28672
    s_addc_u32 s47, s47, 0
    global_load_lds_dwordx4 v112, s[46:47] nt
    s_waitcnt vmcnt(39)
    s_mov_b32 m0, 102400
    s_add_u32 s46, s46, 28672
    s_addc_u32 s47, s47, 0
    global_load_lds_dwordx4 v112, s[46:47] nt
    s_waitcnt vmcnt(39)
    s_mov_b32 m0, 103424
    s_add_u32 s46, s46, 28672
    s_addc_u32 s47, s47, 0
    global_load_lds_dwordx4 v112, s[46:47] nt
    s_waitcnt vmcnt(39)
    s_mov_b32 m0, 104448
    s_add_u32 s46, s46, 28672
    s_addc_u32 s47, s47, 0
    global_load_lds_dwordx4 v112, s[46:47] nt
    s_waitcnt vmcnt(39)
    s_mov_b32 m0, 105472
    s_add_u32 s46, s46, 28672
    s_addc_u32 s47, s47, 0
    global_load_lds_dwordx4 v112, s[46:47] nt
    s_waitcnt vmcnt(39)
    s_mov_b32 m0, 106496
s_nop 0
    global_load_lds_dwordx4 v112, s[48:49] nt
    s_waitcnt vmcnt(39)
    s_mov_b32 m0, 107520
    s_add_u32 s48, s48, 28672
    s_addc_u32 s49, s49, 0
    global_load_lds_dwordx4 v112, s[48:49] nt
    s_waitcnt vmcnt(39)
    s_mov_b32 m0, 108544
    s_add_u32 s48, s48, 28672
    s_addc_u32 s49, s49, 0
    global_load_lds_dwordx4 v112, s[48:49] nt
    s_waitcnt vmcnt(39)
    s_mov_b32 m0, 109568
    s_add_u32 s48, s48, 28672
    s_addc_u32 s49, s49, 0
    global_load_lds_dwordx4 v112, s[48:49] nt
    s_waitcnt vmcnt(39)
    s_mov_b32 m0, 110592
    s_add_u32 s48, s48, 28672
    s_addc_u32 s49, s49, 0
    global_load_lds_dwordx4 v112, s[48:49] nt
    s_waitcnt vmcnt(39)
    s_mov_b32 m0, 111616
    s_add_u32 s48, s48, 28672
    s_addc_u32 s49, s49, 0
    global_load_lds_dwordx4 v112, s[48:49] nt
    s_waitcnt vmcnt(39)
    s_mov_b32 m0, 112640
    s_add_u32 s48, s48, 28672
    s_addc_u32 s49, s49, 0
    global_load_lds_dwordx4 v112, s[48:49] nt
    s_waitcnt vmcnt(39)
    s_mov_b32 m0, 113664
    s_add_u32 s48, s48, 28672
    s_addc_u32 s49, s49, 0
    global_load_lds_dwordx4 v112, s[48:49] nt
    s_waitcnt vmcnt(39)
    s_mov_b32 m0, 114688
s_nop 0
    global_load_lds_dwordx4 v113, s[50:51] nt
    s_waitcnt vmcnt(39)
    s_mov_b32 m0, 115712
    s_add_u32 s50, s50, 4096
    s_addc_u32 s51, s51, 0
    global_load_lds_dwordx4 v114, s[50:51] nt
    s_waitcnt vmcnt(39)
    s_mov_b32 m0, 116736
    s_add_u32 s50, s50, 4096
    s_addc_u32 s51, s51, 0
    global_load_lds_dwordx4 v113, s[50:51] nt
    s_waitcnt vmcnt(39)
    s_mov_b32 m0, 117760
    s_add_u32 s50, s50, 4096
    s_addc_u32 s51, s51, 0
    global_load_lds_dwordx4 v114, s[50:51] nt
    s_waitcnt vmcnt(39)
    s_mov_b32 m0, 118784
    s_add_u32 s50, s50, 4096
    s_addc_u32 s51, s51, 0
    global_load_lds_dwordx4 v113, s[50:51] nt
    s_waitcnt vmcnt(39)
    s_mov_b32 m0, 119808
    s_add_u32 s50, s50, 4096
    s_addc_u32 s51, s51, 0
    global_load_lds_dwordx4 v114, s[50:51] nt
    s_waitcnt vmcnt(39)
    s_mov_b32 m0, 120832
    s_add_u32 s50, s50, 4096
    s_addc_u32 s51, s51, 0
    global_load_lds_dwordx4 v113, s[50:51] nt
    s_waitcnt vmcnt(39)
    s_mov_b32 m0, 121856
    s_add_u32 s50, s50, 4096
    s_addc_u32 s51, s51, 0
    global_load_lds_dwordx4 v114, s[50:51] nt
    s_waitcnt vmcnt(8)
    s_mov_b64 exec, 1
    ds_add_u32 v5, v6 offset:36
    s_mov_b64 exec, -1
    s_waitcnt vmcnt(0)
    s_mov_b64 exec, 1
    ds_add_u32 v5, v6 offset:40
    s_mov_b64 exec, -1
    s_endpgm
L_compute:
    s_lshr_b32 s9, s5, 3
    s_and_b32 s7, s5, 7
    s_lshl_b32 s8, s7, 7
    s_lshl_b32 s10, s3, 5
    s_add_u32 s8, s8, s10
    v_lshlrev_b32 v7, 3, v3
    v_add_u32 v7, s8, v7
    s_lshl_b32 s8, s5, 5
    s_lshl_b32 s10, s3, 3
    s_add_u32 s8, s8, s10
    v_mov_b32 v8, s8
    s_cmp_eq_u32 s4, 7
    s_cselect_b64 s[10:11], -1, 0
    v_cndmask_b32 v7, v7, v8, s[10:11]
    global_load_dwordx2 v[28:29], v7, s[16:17]
    s_mul_i32 s8, s4, 135168
    s_add_u32 s8, s8, 1048576
    s_add_u32 s40, s38, s8
    s_addc_u32 s41, s39, 0
    s_mul_i32 s8, s5, 4224
    s_add_u32 s42, s40, s8
    s_addc_u32 s43, s41, 0
    v_mov_b32 v32, 0
    v_mov_b32 v33, 0
    v_mov_b32 v34, 0
    v_mov_b32 v35, 0
    s_lshl_b32 s8, s3, 10
    v_add_u32 v40, s8, v4
    global_load_dword v15, v40, s[42:43] nt
    global_store_dwordx4 v40, v[32:35], s[42:43]
    s_lshl_b32 s8, s4, 11
    s_add_u32 s8, s8, 5505024
    s_add_u32 s14, s38, s8
    s_addc_u32 s15, s39, 0
    v_lshlrev_b32 v41, 2, v1
    v_lshlrev_b32 v7, 5, v1
    global_load_dword v15, v7, s[14:15] nt
    s_mov_b32 s44, s40
    s_mov_b32 s45, s41
    s_add_u32 s46, s40, 2097152
    s_addc_u32 s47, s41, 0
    s_add_u32 s48, s42, 2097152
    s_addc_u32 s49, s43, 0
    s_mov_b32 s50, 0
    s_mov_b32 s51, 0
    s_add_u32 s52, s38, 5242880
    s_addc_u32 s53, s39, 0
    s_add_u32 s54, s38, 5373952
    s_addc_u32 s55, s39, 0
    s_mov_b32 s62, 0
    s_lshl_b32 s8, s7, 5
    s_lshl_b32 s10, s4, 2
    s_add_u32 s8, s8, s10
    s_add_u32 s8, s8, s9
    s_mul_i32 s10, s9, 56
    s_lshl_b32 s11, s4, 3
    s_add_u32 s10, s10, s11
    s_add_u32 s10, s10, s7
    s_add_u32 s10, s10, 256
    s_cmp_eq_u32 s4, 7
    s_cselect_b32 s10, s8, s10
    v_mov_b32 v7, s8
    v_writelane_b32 v7, s10, 1
    v_lshlrev_b32 v7, 9, v7
    s_lshl_b32 s8, s3, 7
    v_add_u32 v7, s8, v7
    s_mov_b64 exec, 3
    global_load_dword v15, v7, s[52:53] nt
    s_mov_b64 exec, -1
    v_mov_b32 v36, 0x7060500
    v_mov_b32 v37, 0x7060501
    v_mov_b32 v38, 0x7060502
    v_mov_b32 v39, 0x7060503
    v_lshrrev_b32 v42, 2, v2
    v_and_b32 v43, 3, v1
    v_cmp_eq_u32 s[68:69], 0, v2
    v_cmp_gt_u32 s[70:71], 8, v2
    v_cmp_eq_u32 s[72:73], 1, v42
    v_cmp_gt_u32 s[74:75], 4, v2
    v_and_b32 v7, 2, v2
    v_cmp_ne_u32 s[76:77], 0, v7
    v_and_b32 v7, 1, v2
    v_cmp_ne_u32 s[66:67], 0, v7
    v_lshl_add_u32 v7, v3, 2, v42
    v_lshlrev_b32 v44, 7, v7
    v_bfe_u32 v8, v7, 1, 2
    v_lshlrev_b32 v8, 1, v8
    v_lshrrev_b32 v9, 1, v43
    s_lshl_b32 s8, s3, 1
    v_add_u32 v9, s8, v9
    v_xor_b32 v9, v9, v8
    v_lshl_add_u32 v44, v9, 4, v44
    v_and_b32 v9, 1, v43
    v_lshl_add_u32 v44, v9, 3, v44
    v_add_u32 v44, 65536, v44
    v_lshlrev_b32 v46, 8, v7
    v_and_b32 v8, 7, v7
    v_lshlrev_b32 v8, 1, v8
    v_lshrrev_b32 v10, 1, v43
    s_lshl_b32 s8, s3, 2
    v_add_u32 v10, s8, v10
    v_xor_b32 v10, v10, v8
    v_lshl_add_u32 v46, v10, 4, v46
    v_lshl_add_u32 v46, v9, 3, v46
    v_xor_b32 v47, 32, v46
    s_lshl_b32 s8, s3, 6
    v_lshlrev_b32 v48, 4, v3
    v_add_u32 v48, s8, v48
    v_lshlrev_b32 v7, 3, v42
    v_and_b32 v8, 3, v2
    v_lshl_add_u32 v7, v8, 1, v7
    s_lshr_b32 s8, s3, 1
    v_add_u32 v7, s8, v7
    v_mul_u32_u24 v7, 4224, v7
    s_and_b32 s8, s3, 1
    s_lshl_b32 s8, s8, 7
    v_lshl_add_u32 v49, v3, 5, v7
    v_add_u32 v49, s8, v49
    s_lshl_b32 s8, s3, 10
    s_lshl_b32 s10, s9, 8
    s_add_u32 s8, s8, s10
    s_add_u32 s8, s8, 122880
    v_lshlrev_b32 v50, 4, v3
    v_add_u32 v50, s8, v50
    v_add_u32 v14, 122880, v40
    s_waitcnt vmcnt(5)
    v_lshlrev_b32 v52, 16, v24
    v_and_b32 v53, 0xffff0000, v24
    v_lshlrev_b32 v54, 16, v25
    v_and_b32 v55, 0xffff0000, v25
    v_lshlrev_b32 v56, 16, v26
    v_and_b32 v57, 0xffff0000, v26
    v_lshlrev_b32 v58, 16, v27
    v_and_b32 v59, 0xffff0000, v27
    v_add_f32 v7, v52, v53
    v_mul_f32 v8, v52, v52
    v_fmac_f32 v8, v53, v53
    v_add_f32 v7, v7, v54
    v_fmac_f32 v8, v54, v54
    v_add_f32 v7, v7, v55
    v_fmac_f32 v8, v55, v55
    v_add_f32 v7, v7, v56
    v_fmac_f32 v8, v56, v56
    v_add_f32 v7, v7, v57
    v_fmac_f32 v8, v57, v57
    v_add_f32 v7, v7, v58
    v_fmac_f32 v8, v58, v58
    v_add_f32 v7, v7, v59
    v_fmac_f32 v8, v59, v59
s_nop 0
    v_add_f32_dpp v7, v7, v7 row_ror:1 row_mask:0xf bank_mask:0xf
    v_add_f32_dpp v8, v8, v8 row_ror:1 row_mask:0xf bank_mask:0xf
s_nop 0
    v_add_f32_dpp v7, v7, v7 row_ror:2 row_mask:0xf bank_mask:0xf
    v_add_f32_dpp v8, v8, v8 row_ror:2 row_mask:0xf bank_mask:0xf
s_nop 0
    v_add_f32_dpp v7, v7, v7 row_ror:4 row_mask:0xf bank_mask:0xf
    v_add_f32_dpp v8, v8, v8 row_ror:4 row_mask:0xf bank_mask:0xf
s_nop 0
    v_add_f32_dpp v7, v7, v7 row_ror:8 row_mask:0xf bank_mask:0xf
    v_add_f32_dpp v8, v8, v8 row_ror:8 row_mask:0xf bank_mask:0xf
s_nop 0
    v_add_f32_dpp v7, v7, v7 row_bcast:15 row_mask:0xa bank_mask:0xf
    v_add_f32_dpp v8, v8, v8 row_bcast:15 row_mask:0xa bank_mask:0xf
s_nop 0
    v_add_f32_dpp v7, v7, v7 row_bcast:31 row_mask:0xc bank_mask:0xf
    v_add_f32_dpp v8, v8, v8 row_bcast:31 row_mask:0xc bank_mask:0xf
    v_readlane_b32 s8, v7, 63
    v_readlane_b32 s10, v8, 63
s_nop 0
    v_mov_b32 v7, s8
    v_mov_b32 v8, s10
    s_mov_b32 s8, 0x3b000000
    v_mul_f32 v7, s8, v7
    v_mul_f32 v8, s8, v8
    v_fma_f32 v8, -v7, v7, v8
    v_max_f32 v8, 0, v8
    v_cvt_pk_bf16_f32 v8, v8, v8
    v_and_b32 v8, 0xffff0000, v8
    v_add_f32 v8, 0x3727c5ac, v8
    v_cvt_pk_bf16_f32 v8, v8, v8
    v_and_b32 v8, 0xffff0000, v8
    v_sqrt_f32 v8, v8
    v_cvt_pk_bf16_f32 v7, v7, v7
    v_and_b32 v7, 0xffff0000, v7
    v_cvt_pk_bf16_f32 v8, v8, v8
    v_and_b32 v8, 0xffff0000, v8
    v_rcp_f32 v8, v8
    v_sub_f32 v52, v52, v7
    v_sub_f32 v53, v53, v7
    v_sub_f32 v54, v54, v7
    v_sub_f32 v55, v55, v7
    v_sub_f32 v56, v56, v7
    v_sub_f32 v57, v57, v7
    v_sub_f32 v58, v58, v7
    v_sub_f32 v59, v59, v7
    v_cvt_pk_bf16_f32 v10, v52, v53
    v_lshlrev_b32 v52, 16, v10
    v_and_b32 v53, 0xffff0000, v10
    v_cvt_pk_bf16_f32 v10, v54, v55
    v_lshlrev_b32 v54, 16, v10
    v_and_b32 v55, 0xffff0000, v10
    v_cvt_pk_bf16_f32 v10, v56, v57
    v_lshlrev_b32 v56, 16, v10
    v_and_b32 v57, 0xffff0000, v10
    v_cvt_pk_bf16_f32 v10, v58, v59
    v_lshlrev_b32 v58, 16, v10
    v_and_b32 v59, 0xffff0000, v10
    v_mul_f32 v52, v52, v8
    v_mul_f32 v53, v53, v8
    v_mul_f32 v54, v54, v8
    v_mul_f32 v55, v55, v8
    v_mul_f32 v56, v56, v8
    v_mul_f32 v57, v57, v8
    v_mul_f32 v58, v58, v8
    v_mul_f32 v59, v59, v8
    v_cvt_pk_bf16_f32 v24, v52, v53
    v_cvt_pk_bf16_f32 v25, v54, v55
    v_cvt_pk_bf16_f32 v26, v56, v57
    v_cvt_pk_bf16_f32 v27, v58, v59
    ds_write_b128 v14, v[24:27]
    ds_read_b128 v[60:63], v50 offset:0
    ds_read_b128 v[64:67], v50 offset:64
    ds_read_b128 v[68:71], v50 offset:128
    ds_read_b128 v[72:75], v50 offset:192
    s_waitcnt lgkmcnt(0)
    s_add_u32 s13, s56, 1
    s_and_b32 s13, s13, 0x0fffffff
    s_bfe_u32 s8, s13, 0x70000
    s_or_b32 s57, s8, 0x80
    s_bfe_u32 s8, s13, 0x70007
    s_or_b32 s58, s8, 0x80
    s_bfe_u32 s8, s13, 0x70000
    s_xor_b32 s8, s8, 0x2a
    s_or_b32 s59, s8, 0x80
    s_bfe_u32 s8, s13, 0x7000e
    s_or_b32 s60, s8, 0x80
    s_lshl_b32 s8, s58, 8
    s_or_b32 s56, s57, s8
    s_lshl_b32 s8, s59, 16
    s_or_b32 s56, s56, s8
    s_lshl_b32 s8, s60, 24
    s_or_b32 s56, s56, s8
    s_mul_i32 s12, s57, 0x01010101
    s_lshl_b32 s8, s5, 2
    s_add_u32 s8, s8, s3
    v_mov_b32 v76, s8
    v_mov_b32 v77, s57
    ds_read_b32 v7, v5 offset:0
    s_waitcnt lgkmcnt(0)
    v_cmp_le_u32 vcc, 1, v7
    s_cbranch_vccnz L_lwok_2
    s_mov_b32 s63, 16777216
L_lw_1:
    ds_read_b32 v7, v5 offset:0
    s_sub_u32 s63, s63, 1
    s_cbranch_scc1 L_end
    s_waitcnt lgkmcnt(0)
    v_cmp_le_u32 vcc, 1, v7
    s_cbranch_vccz L_lw_1
L_lwok_2:
    ds_read_b64_tr_b16 v[80:81], v44 offset:0
    ds_read_b64_tr_b16 v[82:83], v44 offset:2048
    ds_read_b64_tr_b16 v[84:85], v44 offset:4096
    ds_read_b64_tr_b16 v[86:87], v44 offset:6144
    ds_read_b64_tr_b16 v[88:89], v44 offset:8192
    ds_read_b64_tr_b16 v[90:91], v44 offset:10240
    ds_read_b64_tr_b16 v[92:93], v44 offset:12288
    ds_read_b64_tr_b16 v[94:95], v44 offset:14336
    s_waitcnt lgkmcnt(6)
    v_mfma_f32_16x16x32_bf16 v[96:99], v[80:83], v[60:63], 0
    s_waitcnt lgkmcnt(4)
    v_mfma_f32_16x16x32_bf16 v[96:99], v[84:87], v[64:67], v[96:99]
    s_waitcnt lgkmcnt(2)
    v_mfma_f32_16x16x32_bf16 v[96:99], v[88:91], v[68:71], v[96:99]
    s_waitcnt lgkmcnt(0)
    v_mfma_f32_16x16x32_bf16 v[96:99], v[92:95], v[72:75], v[96:99]
s_nop 7
    v_perm_b32 v96, v96, s56, v36
    v_perm_b32 v97, v97, s56, v37
    v_perm_b32 v98, v98, s56, v38
    v_perm_b32 v99, v99, s56, v39
    s_mov_b64 exec, s[68:69]
    global_store_dwordx4 v48, v[96:99], s[42:43] offset:0
    s_mov_b64 exec, -1
    v_add_u32 v156, 126976, v4
    s_lshl_b32 s8, s3, 13
    v_lshlrev_b32 v160, 8, v2
    v_add_u32 v160, s8, v160
    v_xor_b32 v8, v3, v2
    v_lshl_add_u32 v160, v8, 4, v160
    v_xor_b32 v161, 64, v160
    v_xor_b32 v162, 128, v160
    v_xor_b32 v163, 192, v160
    v_lshlrev_b32 v165, 6, v2
    v_add_u32 v165, 135168, v165
    s_lshl_b32 s8, s3, 4
    v_lshl_add_u32 v164, v3, 2, v165
    v_add_u32 v164, s8, v164
    v_lshlrev_b32 v167, 4, v2
    v_add_u32 v167, 135168, v167
    s_lshl_b32 s8, s3, 2
    v_add_u32 v166, s8, v167
    v_and_b32 v7, 1, v42
    v_lshlrev_b32 v7, 1, v7
    v_add_u32 v168, 0x07060500, v7
    v_add_u32 v169, 0x07060501, v7
    v_and_b32 v7, 3, v2
    v_lshlrev_b32 v170, 9, v7
    v_lshl_add_u32 v170, v42, 6, v170
    v_lshl_add_u32 v170, v3, 4, v170
    s_lshl_b32 s8, s3, 7
    v_add_u32 v170, s8, v170
    s_lshl_b32 s10, s9, 9
    s_add_u32 s10, s10, s8
    v_mul_u32_u24 v7, 4224, v2
    v_lshl_add_u32 v172, v3, 4, v7
    v_add_u32 v172, s10, v172
    v_add_u32 v173, 67584, v172
    s_lshl_b32 s10, s9, 4
    v_add_u32 v174, s10, v7
    v_add_u32 v175, 67584, v174
    s_lshl_b32 s8, s3, 7
    v_add_u32 v177, s8, v41
    s_add_u32 s8, s8, s5
    v_mov_b32 v176, s8
    s_lshl_b32 s8, s9, 7
    s_lshl_b32 s10, s7, 2
    s_add_u32 s8, s8, s10
    s_add_u32 s8, s8, s3
    v_mov_b32 v178, s8
    s_lshr_b32 s8, s7, 1
    s_lshl_b32 s8, s8, 7
    v_add_u32 v179, s8, v41
    v_add_u32 v180, 137216, v48
    v_lshlrev_b32 v181, 4, v3
    v_add_u32 v181, 137216, v181
    s_lshl_b32 s8, s7, 5
    s_lshl_b32 s10, s4, 2
    s_add_u32 s8, s8, s10
    s_add_u32 s8, s8, s9
    s_lshl_b32 s8, s8, 9
    s_lshl_b32 s10, s3, 6
    s_add_u32 s8, s8, s10
    v_add_u32 v182, s8, v48
    s_lshl_b32 s8, s7, 14
    s_add_u32 s8, s8, s10
    v_lshl_add_u32 v186, v2, 8, v48
    v_lshl_add_u32 v184, v2, 9, v48
    v_add_u32 v184, s8, v184
    v_add_u32 v185, 8192, v184
    s_lshr_b32 s8, s3, 1
    s_lshl_b32 s8, s8, 6
    s_and_b32 s10, s3, 1
    s_lshl_b32 s10, s10, 3
    s_add_u32 s8, s8, s10
    v_lshlrev_b32 v188, 4, v3
    v_add_u32 v188, 137472, v188
    v_add_u32 v187, s8, v188
    v_and_b32 v7, 1, v2
    v_lshl_add_u32 v189, v7, 7, v188
    s_lshr_b32 s8, s7, 1
    s_mul_i32 s8, s8, 33792
    s_and_b32 s10, s7, 1
    s_lshl_b32 s10, s10, 7
    s_lshl_b32 s11, s3, 4
    s_add_u32 s10, s10, s11
    v_and_b32 v7, 7, v1
    v_mul_u32_u24 v7, 4224, v7
    v_add_u32 v190, s8, v7
    v_bfe_u32 v8, v1, 3, 2
    v_lshl_add_u32 v8, v8, 8, v190
    v_lshrrev_b32 v7, 5, v1
    v_lshl_add_u32 v8, v7, 6, v8
    v_add_u32 v191, s10, v8
    v_lshlrev_b32 v192, 3, v7
    v_lshl_add_u32 v192, v43, 1, v192
    s_add_u32 s11, s11, 137984
    v_add_u32 v192, s11, v192
    v_lshlrev_b32 v193, 4, v3
    v_add_u32 v193, 137984, v193
    s_mul_i32 s8, s9, 56
    s_lshl_b32 s10, s4, 3
    s_add_u32 s8, s8, s10
    s_add_u32 s8, s8, s7
    s_lshl_b32 s8, s8, 9
    s_lshl_b32 s10, s3, 7
    s_add_u32 s8, s8, s10
    v_lshlrev_b32 v194, 4, v3
    v_add_u32 v194, s8, v194
    v_and_b32 v7, 1, v2
    v_lshl_add_u32 v194, v7, 6, v194
    v_cmp_gt_u32 s[10:11], 2, v2
    s_mov_b64 s[0:1], s[10:11]
    v_add_u32 v200, 114688, v46
    v_add_u32 v201, 114688, v47
    s_waitcnt vmcnt(3)
    v_lshlrev_b32 v204, 16, v28
    v_and_b32 v205, 0xffff0000, v28
    v_lshlrev_b32 v206, 16, v29
    v_and_b32 v207, 0xffff0000, v29
    s_sleep 4
    global_load_dwordx4 v[132:135], v49, s[44:45] offset:0 sc1
    global_load_dwordx4 v[136:139], v49, s[44:45] offset:16 sc1
    s_sleep 10
    global_load_dwordx4 v[140:143], v49, s[44:45] offset:0 sc1
    global_load_dwordx4 v[144:147], v49, s[44:45] offset:16 sc1
    s_mov_b32 s61, 0
L_h1:
    s_waitcnt vmcnt(2)
    v_msad_u8 v128, v132, s57, 0
    v_msad_u8 v128, v133, s58, v128
    v_msad_u8 v128, v134, s59, v128
    v_msad_u8 v128, v135, s60, v128
    v_msad_u8 v128, v136, s57, v128
    v_msad_u8 v128, v137, s58, v128
    v_msad_u8 v128, v138, s59, v128
    v_msad_u8 v128, v139, s60, v128
    v_cmp_ne_u32 vcc, 0, v128
    s_cbranch_vccz L_h1ok0
    s_sleep 4
    global_load_dwordx4 v[132:135], v49, s[44:45] offset:0 sc1
    global_load_dwordx4 v[136:139], v49, s[44:45] offset:16 sc1
    s_waitcnt vmcnt(2)
    v_msad_u8 v128, v140, s57, 0
    v_msad_u8 v128, v141, s58, v128
    v_msad_u8 v128, v142, s59, v128
    v_msad_u8 v128, v143, s60, v128
    v_msad_u8 v128, v144, s57, v128
    v_msad_u8 v128, v145, s58, v128
    v_msad_u8 v128, v146, s59, v128
    v_msad_u8 v128, v147, s60, v128
    v_cmp_ne_u32 vcc, 0, v128
    s_cbranch_vccz L_h1ok1
    s_sleep 4
    global_load_dwordx4 v[140:143], v49, s[44:45] offset:0 sc1
    global_load_dwordx4 v[144:147], v49, s[44:45] offset:16 sc1
    s_add_u32 s61, s61, 1
    s_and_b32 s6, s61, 127
    s_cbranch_scc1 L_h1nx
    s_call_b64 s[64:65], L_panic
L_h1nx:
    s_xor_b32 s44, s44, s50
    s_xor_b32 s45, s45, s51
    s_branch L_h1
L_h1ok0:
    v_add_f32_dpp v104, v132, v132 row_ror:4 row_mask:0xf bank_mask:0xf
    v_add_f32_dpp v105, v133, v133 row_ror:4 row_mask:0xf bank_mask:0xf
    v_add_f32_dpp v106, v134, v134 row_ror:4 row_mask:0xf bank_mask:0xf
    v_add_f32_dpp v107, v135, v135 row_ror:4 row_mask:0xf bank_mask:0xf
    v_add_f32_dpp v108, v136, v136 row_ror:4 row_mask:0xf bank_mask:0xf
    v_add_f32_dpp v109, v137, v137 row_ror:4 row_mask:0xf bank_mask:0xf
    v_add_f32_dpp v110, v138, v138 row_ror:4 row_mask:0xf bank_mask:0xf
    v_add_f32_dpp v111, v139, v139 row_ror:4 row_mask:0xf bank_mask:0xf
    s_branch L_h1done
L_h1ok1:
    v_add_f32_dpp v104, v140, v140 row_ror:4 row_mask:0xf bank_mask:0xf
    v_add_f32_dpp v105, v141, v141 row_ror:4 row_mask:0xf bank_mask:0xf
    v_add_f32_dpp v106, v142, v142 row_ror:4 row_mask:0xf bank_mask:0xf
    v_add_f32_dpp v107, v143, v143 row_ror:4 row_mask:0xf bank_mask:0xf
    v_add_f32_dpp v108, v144, v144 row_ror:4 row_mask:0xf bank_mask:0xf
    v_add_f32_dpp v109, v145, v145 row_ror:4 row_mask:0xf bank_mask:0xf
    v_add_f32_dpp v110, v146, v146 row_ror:4 row_mask:0xf bank_mask:0xf
    v_add_f32_dpp v111, v147, v147 row_ror:4 row_mask:0xf bank_mask:0xf
L_h1done:
    s_nop 1
    v_add_f32_dpp v104, v104, v104 row_ror:8 row_mask:0xf bank_mask:0xf
    v_add_f32_dpp v105, v105, v105 row_ror:8 row_mask:0xf bank_mask:0xf
    v_add_f32_dpp v106, v106, v106 row_ror:8 row_mask:0xf bank_mask:0xf
    v_add_f32_dpp v107, v107, v107 row_ror:8 row_mask:0xf bank_mask:0xf
    v_add_f32_dpp v108, v108, v108 row_ror:8 row_mask:0xf bank_mask:0xf
    v_add_f32_dpp v109, v109, v109 row_ror:8 row_mask:0xf bank_mask:0xf
    v_add_f32_dpp v110, v110, v110 row_ror:8 row_mask:0xf bank_mask:0xf
    v_add_f32_dpp v111, v111, v111 row_ror:8 row_mask:0xf bank_mask:0xf
    v_cvt_pk_bf16_f32 v24, v104, v105
    v_cvt_pk_bf16_f32 v25, v106, v107
    v_cvt_pk_bf16_f32 v26, v108, v109
    v_cvt_pk_bf16_f32 v27, v110, v111
    v_add_u32 v7, 126976, v40
    ds_write_b128 v7, v[24:27]
    s_mov_b64 exec, 1
    ds_add_u32 v5, v6 offset:4
    s_mov_b64 exec, -1
    ds_read_b32 v11, v5 offset:24
    s_waitcnt lgkmcnt(0)
    v_cmp_le_u32 vcc, 1, v11
    s_cbranch_vccnz L_lwok_4
    s_mov_b32 s63, 16777216
L_lw_3:
    ds_read_b32 v11, v5 offset:24
    s_sub_u32 s63, s63, 1
    s_cbranch_scc1 L_end
    s_waitcnt lgkmcnt(0)
    v_cmp_le_u32 vcc, 1, v11
    s_cbranch_vccz L_lw_3
L_lwok_4:
    ds_read_b128 v[208:211], v160 offset:0
    ds_read_b128 v[212:215], v161 offset:0
    ds_read_b128 v[216:219], v162 offset:0
    ds_read_b128 v[220:223], v163 offset:0
    ds_read_b128 v[224:227], v160 offset:4096
    ds_read_b128 v[228:231], v161 offset:4096
    ds_read_b128 v[232:235], v162 offset:4096
    ds_read_b128 v[236:239], v163 offset:4096
    s_mov_b32 s63, 16777216
L_lw_5:
    ds_read_b32 v11, v5 offset:4
    s_sub_u32 s63, s63, 1
    s_cbranch_scc1 L_end
    s_waitcnt lgkmcnt(0)
    v_cmp_le_u32 vcc, 4, v11
    s_cbranch_vccz L_lw_5
    ds_read_b128 v[60:63], v156 offset:0
    ds_read_b128 v[64:67], v156 offset:1024
    ds_read_b128 v[68:71], v156 offset:2048
    ds_read_b128 v[72:75], v156 offset:3072
    s_waitcnt lgkmcnt(0)
L_lwok_6:
    v_mfma_f32_16x16x32_bf16 v[96:99], v[208:211], v[60:63], 0
    v_mfma_f32_16x16x32_bf16 v[100:103], v[224:227], v[60:63], 0
    v_mfma_f32_16x16x32_bf16 v[96:99], v[212:215], v[64:67], v[96:99]
    v_mfma_f32_16x16x32_bf16 v[100:103], v[228:231], v[64:67], v[100:103]
    v_mfma_f32_16x16x32_bf16 v[96:99], v[216:219], v[68:71], v[96:99]
    v_mfma_f32_16x16x32_bf16 v[100:103], v[232:235], v[68:71], v[100:103]
    v_mfma_f32_16x16x32_bf16 v[96:99], v[220:223], v[72:75], v[96:99]
    v_mfma_f32_16x16x32_bf16 v[100:103], v[236:239], v[72:75], v[100:103]
    s_mov_b32 s8, 0x3db504f3
s_nop 5
    v_cvt_pk_bf16_f32 v7, v96, v97
    v_lshlrev_b32 v52, 16, v7
    v_and_b32 v53, 0xffff0000, v7
    v_cvt_pk_bf16_f32 v7, v98, v99
    v_lshlrev_b32 v54, 16, v7
    v_and_b32 v55, 0xffff0000, v7
    v_cvt_pk_bf16_f32 v7, v100, v101
    v_lshlrev_b32 v56, 16, v7
    v_and_b32 v57, 0xffff0000, v7
    v_cvt_pk_bf16_f32 v7, v102, v103
    v_lshlrev_b32 v58, 16, v7
    v_and_b32 v59, 0xffff0000, v7
    v_mul_f32 v52, s8, v52
    v_mul_f32 v53, s8, v53
    v_mul_f32 v54, s8, v54
    v_mul_f32 v55, s8, v55
    v_mul_f32 v56, s8, v56
    v_mul_f32 v57, s8, v57
    v_mul_f32 v58, s8, v58
    v_mul_f32 v59, s8, v59
    v_cvt_pk_bf16_f32 v7, v52, v53
    v_lshlrev_b32 v52, 16, v7
    v_and_b32 v53, 0xffff0000, v7
    v_cvt_pk_bf16_f32 v7, v54, v55
    v_lshlrev_b32 v54, 16, v7
    v_and_b32 v55, 0xffff0000, v7
    v_cvt_pk_bf16_f32 v7, v56, v57
    v_lshlrev_b32 v56, 16, v7
    v_and_b32 v57, 0xffff0000, v7
    v_cvt_pk_bf16_f32 v7, v58, v59
    v_lshlrev_b32 v58, 16, v7
    v_and_b32 v59, 0xffff0000, v7
    v_max3_f32 v7, v52, v53, v54
    v_max3_f32 v8, v55, v56, v57
    v_max3_f32 v7, v7, v58, v59
    v_max_f32 v7, v7, v8
    v_mov_b32 v8, v7
s_nop 1
    v_permlane16_swap_b32 v7, v8
    v_max_f32 v7, v7, v8
    v_mov_b32 v8, v7
s_nop 1
    v_permlane32_swap_b32 v7, v8
    v_max_f32 v7, v7, v8
    s_mov_b32 s8, 0x3fb8aa3b
    v_mul_f32 v8, s8, v7
    v_fma_f32 v52, v52, s8, -v8
    v_fma_f32 v53, v53, s8, -v8
    v_fma_f32 v54, v54, s8, -v8
    v_fma_f32 v55, v55, s8, -v8
    v_fma_f32 v56, v56, s8, -v8
    v_fma_f32 v57, v57, s8, -v8
    v_fma_f32 v58, v58, s8, -v8
    v_fma_f32 v59, v59, s8, -v8
    v_exp_f32 v52, v52
    v_exp_f32 v53, v53
    v_exp_f32 v54, v54
    v_exp_f32 v55, v55
    v_exp_f32 v56, v56
    v_exp_f32 v57, v57
    v_exp_f32 v58, v58
    v_exp_f32 v59, v59
    v_cvt_pk_bf16_f32 v24, v52, v53
    v_cvt_pk_bf16_f32 v25, v54, v55
    v_cvt_pk_bf16_f32 v26, v56, v57
    v_cvt_pk_bf16_f32 v27, v58, v59
    v_add_u32 v8, 131072, v40
    ds_write_b128 v8, v[24:27]
    ds_write_b32 v166, v7
    v_add_f32 v9, v52, v53
    v_add_f32 v10, v54, v55
    v_add_f32 v9, v9, v56
    v_add_f32 v10, v10, v57
    v_add_f32 v9, v9, v58
    v_add_f32 v10, v10, v59
    v_add_f32 v9, v9, v10
    v_mov_b32 v10, v9
s_nop 1
    v_permlane16_swap_b32 v9, v10
    v_add_f32 v9, v9, v10
    v_mov_b32 v10, v9
s_nop 1
    v_permlane32_swap_b32 v9, v10
    v_add_f32 v9, v9, v10
    ds_write_b32 v166, v9 offset:1024
    s_mov_b64 exec, 1
    ds_add_u32 v5, v6 offset:12
    s_mov_b64 exec, -1
    s_mov_b32 s63, 16777216
L_lw_7:
    ds_read_b32 v11, v5 offset:12
    s_sub_u32 s63, s63, 1
    s_cbranch_scc1 L_end
    s_waitcnt lgkmcnt(0)
    v_cmp_le_u32 vcc, 4, v11
    s_cbranch_vccz L_lw_7
    ds_read_b128 v[60:63], v156 offset:4096
    ds_read_b128 v[64:67], v156 offset:5120
    ds_read_b128 v[68:71], v156 offset:6144
    ds_read_b128 v[72:75], v156 offset:7168
    ds_read_b128 v[244:247], v167
    ds_read_b128 v[104:107], v167 offset:1024
    s_waitcnt lgkmcnt(0)
L_lwok_8:
    v_max3_f32 v240, v244, v245, v246
    v_max_f32 v240, v240, v247
    v_sub_f32 v244, v244, v240
    v_sub_f32 v245, v245, v240
    v_sub_f32 v246, v246, v240
    v_sub_f32 v247, v247, v240
    v_mul_f32 v244, s8, v244
    v_mul_f32 v245, s8, v245
    v_mul_f32 v246, s8, v246
    v_mul_f32 v247, s8, v247
    v_exp_f32 v244, v244
    v_exp_f32 v245, v245
    v_exp_f32 v246, v246
    v_exp_f32 v247, v247
    v_mul_f32 v241, v244, v104
    v_fmac_f32 v241, v245, v105
    v_fmac_f32 v241, v246, v106
    v_fmac_f32 v241, v247, v107
    v_rcp_f32 v242, v241
    v_log_f32 v241, v241
    v_mul_f32 v244, v242, v244
    v_mul_f32 v245, v242, v245
    v_mul_f32 v246, v242, v246
    v_mul_f32 v247, v242, v247
    v_fmac_f32 v241, s8, v240
    ds_read_b32 v11, v5 offset:28
    s_waitcnt lgkmcnt(0)
    v_cmp_le_u32 vcc, 1, v11
    s_cbranch_vccnz L_lwok_10
    s_mov_b32 s63, 16777216
L_lw_9:
    ds_read_b32 v11, v5 offset:28
    s_sub_u32 s63, s63, 1
    s_cbranch_scc1 L_end
    s_waitcnt lgkmcnt(0)
    v_cmp_le_u32 vcc, 1, v11
    s_cbranch_vccz L_lw_9
L_lwok_10:
    ds_read_b64_tr_b16 v[208:209], v46 offset:32768
    ds_read_b64_tr_b16 v[210:211], v46 offset:36864
    ds_read_b64_tr_b16 v[212:213], v47 offset:32768
    ds_read_b64_tr_b16 v[214:215], v47 offset:36864
    ds_read_b64_tr_b16 v[216:217], v46 offset:40960
    ds_read_b64_tr_b16 v[218:219], v46 offset:45056
    ds_read_b64_tr_b16 v[220:221], v47 offset:40960
    ds_read_b64_tr_b16 v[222:223], v47 offset:45056
    ds_read_b64_tr_b16 v[224:225], v46 offset:49152
    ds_read_b64_tr_b16 v[226:227], v46 offset:53248
    ds_read_b64_tr_b16 v[228:229], v47 offset:49152
    ds_read_b64_tr_b16 v[230:231], v47 offset:53248
    ds_read_b64_tr_b16 v[232:233], v46 offset:57344
    ds_read_b64_tr_b16 v[234:235], v46 offset:61440
    ds_read_b64_tr_b16 v[236:237], v47 offset:57344
    ds_read_b64_tr_b16 v[238:239], v47 offset:61440
    s_waitcnt lgkmcnt(12)
    v_mfma_f32_16x16x32_bf16 v[80:83], v[208:211], v[60:63], 0
    v_mfma_f32_16x16x32_bf16 v[104:107], v[212:215], v[60:63], 0
    s_waitcnt lgkmcnt(8)
    v_mfma_f32_16x16x32_bf16 v[84:87], v[216:219], v[64:67], 0
    v_mfma_f32_16x16x32_bf16 v[108:111], v[220:223], v[64:67], 0
    s_waitcnt lgkmcnt(4)
    v_mfma_f32_16x16x32_bf16 v[88:91], v[224:227], v[68:71], 0
    v_mfma_f32_16x16x32_bf16 v[112:115], v[228:231], v[68:71], 0
    s_waitcnt lgkmcnt(0)
    v_mfma_f32_16x16x32_bf16 v[92:95], v[232:235], v[72:75], 0
    v_mfma_f32_16x16x32_bf16 v[116:119], v[236:239], v[72:75], 0
    v_cndmask_b32 v80, v80, v104, s[72:73]
    v_cndmask_b32 v81, v81, v105, s[72:73]
    v_cndmask_b32 v82, v82, v106, s[72:73]
    v_cndmask_b32 v83, v83, v107, s[72:73]
    v_mul_f32 v96, v244, v80
    v_mul_f32 v97, v244, v81
    v_mul_f32 v98, v244, v82
    v_mul_f32 v99, v244, v83
    v_cndmask_b32 v84, v84, v108, s[72:73]
    v_cndmask_b32 v85, v85, v109, s[72:73]
    v_cndmask_b32 v86, v86, v110, s[72:73]
    v_cndmask_b32 v87, v87, v111, s[72:73]
    v_fmac_f32 v96, v245, v84
    v_fmac_f32 v97, v245, v85
    v_fmac_f32 v98, v245, v86
    v_fmac_f32 v99, v245, v87
    v_cndmask_b32 v88, v88, v112, s[72:73]
    v_cndmask_b32 v89, v89, v113, s[72:73]
    v_cndmask_b32 v90, v90, v114, s[72:73]
    v_cndmask_b32 v91, v91, v115, s[72:73]
    v_fmac_f32 v96, v246, v88
    v_fmac_f32 v97, v246, v89
    v_fmac_f32 v98, v246, v90
    v_fmac_f32 v99, v246, v91
    v_cndmask_b32 v92, v92, v116, s[72:73]
    v_cndmask_b32 v93, v93, v117, s[72:73]
    v_cndmask_b32 v94, v94, v118, s[72:73]
    v_cndmask_b32 v95, v95, v119, s[72:73]
    v_fmac_f32 v96, v247, v92
    v_fmac_f32 v97, v247, v93
    v_fmac_f32 v98, v247, v94
    v_fmac_f32 v99, v247, v95
    v_perm_b32 v96, v96, s56, v168
    v_perm_b32 v97, v97, s56, v169
    v_perm_b32 v98, v98, v241, v168
    v_perm_b32 v99, v99, v241, v169
    s_mov_b64 exec, s[70:71]
    global_store_dwordx4 v170, v[96:99], s[42:43] offset:2048
    s_mov_b64 exec, 1
    global_store_byte v176, v77, s[14:15]
    s_mov_b64 exec, -1
    s_mov_b64 exec, 0xff
    global_load_dword v148, v177, s[14:15] offset:0 sc1
    s_sleep 1
    global_load_dword v149, v177, s[14:15] offset:0 sc1
    s_sleep 1
    global_load_dword v150, v177, s[14:15] offset:0 sc1
    s_mov_b32 s61, 133
L_hr2:
    s_waitcnt vmcnt(2)
    v_cmp_ne_u32 vcc, s12, v148
    s_cbranch_vccz L_hr2ok
    global_load_dword v148, v177, s[14:15] offset:0 sc1
    s_waitcnt vmcnt(2)
    v_cmp_ne_u32 vcc, s12, v149
    s_cbranch_vccz L_hr2ok
    global_load_dword v149, v177, s[14:15] offset:0 sc1
    s_waitcnt vmcnt(2)
    v_cmp_ne_u32 vcc, s12, v150
    s_cbranch_vccz L_hr2ok
    global_load_dword v150, v177, s[14:15] offset:0 sc1
    s_sub_u32 s61, s61, 1
    s_cbranch_scc0 L_hr2
L_hr2ok:
    s_mov_b64 exec, -1
    s_mov_b32 s10, 0x0c0c0400
    s_mov_b32 s11, 0x04000c0c
    s_mov_b32 s61, 0
    global_load_dwordx4 v[104:107], v172, s[44:45] offset:2048 sc1
    global_load_dwordx4 v[108:111], v172, s[44:45] offset:2112 sc1
    global_load_dwordx4 v[112:115], v173, s[44:45] offset:2048 sc1
    global_load_dwordx4 v[116:119], v173, s[44:45] offset:2112 sc1
    s_mov_b64 exec, 1
    ds_add_u32 v5, v6 offset:44
    s_mov_b64 exec, -1
    ds_read_b32 v11, v5 offset:32
    s_waitcnt lgkmcnt(0)
    v_cmp_le_u32 vcc, 1, v11
    s_cbranch_vccnz L_lwok_15
    s_mov_b32 s63, 16777216
L_lw_14:
    ds_read_b32 v11, v5 offset:32
    s_sub_u32 s63, s63, 1
    s_cbranch_scc1 L_end
    s_waitcnt lgkmcnt(0)
    v_cmp_le_u32 vcc, 1, v11
    s_cbranch_vccz L_lw_14
L_lwok_15:
    ds_read_b64_tr_b16 v[80:81], v44 offset:16384
    ds_read_b64_tr_b16 v[82:83], v44 offset:18432
    ds_read_b64_tr_b16 v[84:85], v44 offset:20480
    ds_read_b64_tr_b16 v[86:87], v44 offset:22528
    ds_read_b64_tr_b16 v[88:89], v44 offset:24576
    ds_read_b64_tr_b16 v[90:91], v44 offset:26624
    ds_read_b64_tr_b16 v[92:93], v44 offset:28672
    ds_read_b64_tr_b16 v[94:95], v44 offset:30720
L_pollw_11:
    s_waitcnt vmcnt(0)
    v_msad_u8 v128, v104, s57, 0
    v_msad_u8 v128, v105, s58, v128
    v_msad_u8 v128, v108, s59, v128
    v_msad_u8 v128, v109, s60, v128
    v_msad_u8 v128, v112, s57, v128
    v_msad_u8 v128, v113, s58, v128
    v_msad_u8 v128, v116, s59, v128
    v_msad_u8 v128, v117, s60, v128
    v_cmp_ne_u32 vcc, 0, v128
    s_cbranch_vccz L_pollok_13
    s_add_u32 s61, s61, 1
    s_and_b32 s6, s61, 511
    s_cbranch_scc1 L_pollnx_16
    s_call_b64 s[64:65], L_panic
L_pollnx_16:
    s_xor_b32 s44, s44, s50
    s_xor_b32 s45, s45, s51
    global_load_dwordx4 v[104:107], v172, s[44:45] offset:2048 sc1
    global_load_dwordx4 v[108:111], v172, s[44:45] offset:2112 sc1
    global_load_dwordx4 v[112:115], v173, s[44:45] offset:2048 sc1
    global_load_dwordx4 v[116:119], v173, s[44:45] offset:2112 sc1
    s_branch L_pollw_11
L_pollok_13:
    v_perm_b32 v120, v107, v106, s10
    v_perm_b32 v121, v111, v110, s11
    v_perm_b32 v124, v115, v114, s10
    v_perm_b32 v125, v119, v118, s11
    v_or_b32 v120, v120, v121
    v_or_b32 v124, v124, v125
    v_max_f32 v7, v120, v124
s_nop 1
    v_max_f32_dpp v7, v7, v7 row_ror:1 row_mask:0xf bank_mask:0xf
s_nop 1
    v_max_f32_dpp v7, v7, v7 row_ror:2 row_mask:0xf bank_mask:0xf
s_nop 1
    v_max_f32_dpp v7, v7, v7 row_ror:4 row_mask:0xf bank_mask:0xf
s_nop 1
    v_max_f32_dpp v7, v7, v7 row_ror:8 row_mask:0xf bank_mask:0xf
    v_sub_f32 v120, v120, v7
    v_sub_f32 v124, v124, v7
    v_exp_f32 v120, v120
    v_exp_f32 v124, v124
    v_mul_f32 v104, v120, v104
    v_mul_f32 v105, v120, v105
    v_mul_f32 v106, v120, v106
    v_mul_f32 v107, v120, v107
    v_mul_f32 v108, v120, v108
    v_mul_f32 v109, v120, v109
    v_mul_f32 v110, v120, v110
    v_mul_f32 v111, v120, v111
    v_fmac_f32 v104, v124, v112
    v_fmac_f32 v105, v124, v113
    v_fmac_f32 v106, v124, v114
    v_fmac_f32 v107, v124, v115
    v_fmac_f32 v108, v124, v116
    v_fmac_f32 v109, v124, v117
    v_fmac_f32 v110, v124, v118
    v_fmac_f32 v111, v124, v119
    v_add_f32 v8, v120, v124
s_nop 1
    v_add_f32_dpp v8, v8, v8 row_ror:1 row_mask:0xf bank_mask:0xf
    v_add_f32_dpp v104, v104, v104 row_ror:1 row_mask:0xf bank_mask:0xf
    v_add_f32_dpp v105, v105, v105 row_ror:1 row_mask:0xf bank_mask:0xf
    v_add_f32_dpp v106, v106, v106 row_ror:1 row_mask:0xf bank_mask:0xf
    v_add_f32_dpp v107, v107, v107 row_ror:1 row_mask:0xf bank_mask:0xf
    v_add_f32_dpp v108, v108, v108 row_ror:1 row_mask:0xf bank_mask:0xf
    v_add_f32_dpp v109, v109, v109 row_ror:1 row_mask:0xf bank_mask:0xf
    v_add_f32_dpp v110, v110, v110 row_ror:1 row_mask:0xf bank_mask:0xf
    v_add_f32_dpp v111, v111, v111 row_ror:1 row_mask:0xf bank_mask:0xf
    v_add_f32_dpp v8, v8, v8 row_ror:2 row_mask:0xf bank_mask:0xf
    v_add_f32_dpp v104, v104, v104 row_ror:2 row_mask:0xf bank_mask:0xf
    v_add_f32_dpp v105, v105, v105 row_ror:2 row_mask:0xf bank_mask:0xf
    v_add_f32_dpp v106, v106, v106 row_ror:2 row_mask:0xf bank_mask:0xf
    v_add_f32_dpp v107, v107, v107 row_ror:2 row_mask:0xf bank_mask:0xf
    v_add_f32_dpp v108, v108, v108 row_ror:2 row_mask:0xf bank_mask:0xf
    v_add_f32_dpp v109, v109, v109 row_ror:2 row_mask:0xf bank_mask:0xf
    v_add_f32_dpp v110, v110, v110 row_ror:2 row_mask:0xf bank_mask:0xf
    v_add_f32_dpp v111, v111, v111 row_ror:2 row_mask:0xf bank_mask:0xf
    v_add_f32_dpp v8, v8, v8 row_ror:4 row_mask:0xf bank_mask:0xf
    v_add_f32_dpp v104, v104, v104 row_ror:4 row_mask:0xf bank_mask:0xf
    v_add_f32_dpp v105, v105, v105 row_ror:4 row_mask:0xf bank_mask:0xf
    v_add_f32_dpp v106, v106, v106 row_ror:4 row_mask:0xf bank_mask:0xf
    v_add_f32_dpp v107, v107, v107 row_ror:4 row_mask:0xf bank_mask:0xf
    v_add_f32_dpp v108, v108, v108 row_ror:4 row_mask:0xf bank_mask:0xf
    v_add_f32_dpp v109, v109, v109 row_ror:4 row_mask:0xf bank_mask:0xf
    v_add_f32_dpp v110, v110, v110 row_ror:4 row_mask:0xf bank_mask:0xf
    v_add_f32_dpp v111, v111, v111 row_ror:4 row_mask:0xf bank_mask:0xf
    v_add_f32_dpp v8, v8, v8 row_ror:8 row_mask:0xf bank_mask:0xf
    v_add_f32_dpp v104, v104, v104 row_ror:8 row_mask:0xf bank_mask:0xf
    v_add_f32_dpp v105, v105, v105 row_ror:8 row_mask:0xf bank_mask:0xf
    v_add_f32_dpp v106, v106, v106 row_ror:8 row_mask:0xf bank_mask:0xf
    v_add_f32_dpp v107, v107, v107 row_ror:8 row_mask:0xf bank_mask:0xf
    v_add_f32_dpp v108, v108, v108 row_ror:8 row_mask:0xf bank_mask:0xf
    v_add_f32_dpp v109, v109, v109 row_ror:8 row_mask:0xf bank_mask:0xf
    v_add_f32_dpp v110, v110, v110 row_ror:8 row_mask:0xf bank_mask:0xf
    v_add_f32_dpp v111, v111, v111 row_ror:8 row_mask:0xf bank_mask:0xf
    v_rcp_f32 v8, v8
s_nop 0
    v_mul_f32 v104, v8, v104
    v_mul_f32 v105, v8, v105
    v_mul_f32 v106, v8, v106
    v_mul_f32 v107, v8, v107
    v_mul_f32 v108, v8, v108
    v_mul_f32 v109, v8, v109
    v_mul_f32 v110, v8, v110
    v_mul_f32 v111, v8, v111
    v_cvt_pk_bf16_f32 v24, v104, v105
    v_cvt_pk_bf16_f32 v25, v106, v107
    v_cvt_pk_bf16_f32 v26, v108, v109
    v_cvt_pk_bf16_f32 v27, v110, v111
    s_mov_b64 exec, s[68:69]
    ds_write_b128 v180, v[24:27]
    s_mov_b64 exec, 1
    ds_add_u32 v5, v6 offset:16
    s_mov_b64 exec, -1
    s_mov_b32 s63, 16777216
L_lw_17:
    ds_read_b32 v11, v5 offset:16
    s_sub_u32 s63, s63, 1
    s_cbranch_scc1 L_end
    s_waitcnt lgkmcnt(0)
    v_cmp_le_u32 vcc, 4, v11
    s_cbranch_vccz L_lw_17
    ds_read_b128 v[60:63], v181 offset:0
    ds_read_b128 v[64:67], v181 offset:64
    ds_read_b128 v[68:71], v181 offset:128
    ds_read_b128 v[72:75], v181 offset:192
    s_waitcnt lgkmcnt(0)
L_lwok_18:
    v_mfma_f32_16x16x32_bf16 v[96:99], v[80:83], v[60:63], 0
    v_mfma_f32_16x16x32_bf16 v[96:99], v[84:87], v[64:67], v[96:99]
    v_mfma_f32_16x16x32_bf16 v[96:99], v[88:91], v[68:71], v[96:99]
    v_mfma_f32_16x16x32_bf16 v[96:99], v[92:95], v[72:75], v[96:99]
s_nop 7
    v_perm_b32 v96, v96, s56, v36
    v_perm_b32 v97, v97, s56, v37
    v_perm_b32 v98, v98, s56, v38
    v_perm_b32 v99, v99, s56, v39
    s_mov_b64 exec, s[68:69]
    global_store_dwordx4 v182, v[96:99], s[52:53] sc1
    s_mov_b64 exec, -1
    s_cmp_eq_u32 s4, 7
    s_cbranch_scc1 L_final
    s_sleep 16
    global_load_dwordx4 v[132:135], v184, s[52:53] sc1
    global_load_dwordx4 v[136:139], v185, s[52:53] sc1
    ds_read_b32 v11, v5 offset:36
    s_waitcnt lgkmcnt(0)
    v_cmp_le_u32 vcc, 1, v11
    s_cbranch_vccnz L_lwok_20
    s_mov_b32 s63, 16777216
L_lw_19:
    ds_read_b32 v11, v5 offset:36
    s_sub_u32 s63, s63, 1
    s_cbranch_scc1 L_end
    s_waitcnt lgkmcnt(0)
    v_cmp_le_u32 vcc, 1, v11
    s_cbranch_vccz L_lw_19
L_lwok_20:
    ds_read_b64_tr_b16 v[208:209], v44 offset:32768
    ds_read_b64_tr_b16 v[210:211], v44 offset:34816
    ds_read_b64_tr_b16 v[212:213], v44 offset:36864
    ds_read_b64_tr_b16 v[214:215], v44 offset:38912
    ds_read_b64_tr_b16 v[216:217], v44 offset:40960
    ds_read_b64_tr_b16 v[218:219], v44 offset:43008
    ds_read_b64_tr_b16 v[220:221], v44 offset:45056
    ds_read_b64_tr_b16 v[222:223], v44 offset:47104
    ds_read_b32 v11, v5 offset:40
    s_waitcnt lgkmcnt(0)
    v_cmp_le_u32 vcc, 1, v11
    s_cbranch_vccnz L_lwok_22
    s_mov_b32 s63, 16777216
L_lw_21:
    ds_read_b32 v11, v5 offset:40
    s_sub_u32 s63, s63, 1
    s_cbranch_scc1 L_end
    s_waitcnt lgkmcnt(0)
    v_cmp_le_u32 vcc, 1, v11
    s_cbranch_vccz L_lw_21
L_lwok_22:
    ds_read_b64_tr_b16 v[224:225], v200 offset:0
    ds_read_b64_tr_b16 v[226:227], v200 offset:4096
    ds_read_b64_tr_b16 v[228:229], v201 offset:0
    ds_read_b64_tr_b16 v[230:231], v201 offset:4096
    s_mov_b32 s61, 0
L_h3:
    s_waitcnt vmcnt(0)
    v_msad_u8 v128, v132, s57, 0
    v_msad_u8 v128, v133, s58, v128
    v_msad_u8 v128, v134, s59, v128
    v_msad_u8 v128, v135, s60, v128
    v_msad_u8 v128, v136, s57, v128
    v_msad_u8 v128, v137, s58, v128
    v_msad_u8 v128, v138, s59, v128
    v_msad_u8 v128, v139, s60, v128
    v_cmp_ne_u32 vcc, 0, v128
    s_cbranch_vccz L_h3ok0
    global_load_dwordx4 v[132:135], v184, s[52:53] sc1
    global_load_dwordx4 v[136:139], v185, s[52:53] sc1
    s_add_u32 s61, s61, 1
    s_and_b32 s6, s61, 127
    s_cbranch_scc1 L_h3nx
    s_call_b64 s[64:65], L_panic
L_h3nx:
    s_branch L_h3
L_h3ok0:
    v_add_f32 v104, v132, v136
    v_add_f32 v105, v133, v137
    v_add_f32 v106, v134, v138
    v_add_f32 v107, v135, v139
L_h3done:
    s_nop 1
    v_add_f32_dpp v104, v104, v104 row_ror:1 row_mask:0xf bank_mask:0xf
    v_add_f32_dpp v105, v105, v105 row_ror:1 row_mask:0xf bank_mask:0xf
    v_add_f32_dpp v106, v106, v106 row_ror:1 row_mask:0xf bank_mask:0xf
    v_add_f32_dpp v107, v107, v107 row_ror:1 row_mask:0xf bank_mask:0xf
    v_add_f32_dpp v104, v104, v104 row_ror:2 row_mask:0xf bank_mask:0xf
    v_add_f32_dpp v105, v105, v105 row_ror:2 row_mask:0xf bank_mask:0xf
    v_add_f32_dpp v106, v106, v106 row_ror:2 row_mask:0xf bank_mask:0xf
    v_add_f32_dpp v107, v107, v107 row_ror:2 row_mask:0xf bank_mask:0xf
    v_add_f32_dpp v104, v104, v104 row_ror:4 row_mask:0xf bank_mask:0xf
    v_add_f32_dpp v105, v105, v105 row_ror:4 row_mask:0xf bank_mask:0xf
    v_add_f32_dpp v106, v106, v106 row_ror:4 row_mask:0xf bank_mask:0xf
    v_add_f32_dpp v107, v107, v107 row_ror:4 row_mask:0xf bank_mask:0xf
    v_add_f32_dpp v104, v104, v104 row_ror:8 row_mask:0xf bank_mask:0xf
    v_add_f32_dpp v105, v105, v105 row_ror:8 row_mask:0xf bank_mask:0xf
    v_add_f32_dpp v106, v106, v106 row_ror:8 row_mask:0xf bank_mask:0xf
    v_add_f32_dpp v107, v107, v107 row_ror:8 row_mask:0xf bank_mask:0xf
    v_cvt_pk_bf16_f32 v7, v104, v105
    v_lshlrev_b32 v104, 16, v7
    v_and_b32 v105, 0xffff0000, v7
    v_cvt_pk_bf16_f32 v8, v106, v107
    v_lshlrev_b32 v106, 16, v8
    v_and_b32 v107, 0xffff0000, v8
    v_add_f32 v104, v104, v204
    v_add_f32 v105, v105, v205
    v_add_f32 v106, v106, v206
    v_add_f32 v107, v107, v207
    v_cvt_pk_bf16_f32 v24, v104, v105
    v_cvt_pk_bf16_f32 v25, v106, v107
    s_mov_b64 exec, s[68:69]
    ds_write_b64 v187, v[24:25]
    s_mov_b64 exec, -1
    s_waitcnt lgkmcnt(0)
    s_barrier
    ds_read_b128 v[60:63], v189 offset:0
    ds_read_b128 v[64:67], v189 offset:64
    ds_read_b128 v[68:71], v188 offset:0
    ds_read_b128 v[72:75], v188 offset:64
    s_waitcnt lgkmcnt(0)
    v_mfma_f32_16x16x32_bf16 v[240:243], v[68:71], v[60:63], 0
    v_mfma_f32_16x16x32_bf16 v[96:99], v[208:211], v[60:63], 0
    v_mfma_f32_16x16x32_bf16 v[100:103], v[216:219], v[60:63], 0
    v_mfma_f32_16x16x32_bf16 v[240:243], v[72:75], v[64:67], v[240:243]
    v_mfma_f32_16x16x32_bf16 v[96:99], v[212:215], v[64:67], v[96:99]
    v_mfma_f32_16x16x32_bf16 v[100:103], v[220:223], v[64:67], v[100:103]
    s_cmp_lg_u32 s3, 0
    s_cbranch_scc1 L_skipst_23
    s_nop 3
    v_mov_b32_dpp v241, v240 row_shl:1 row_mask:0xf bank_mask:0xf
    v_perm_b32 v240, v240, s56, v36
    v_perm_b32 v241, v241, s56, v37
    v_perm_b32 v242, v242, s56, v38
    v_perm_b32 v243, v243, s56, v39
    s_mov_b64 exec, 1
    global_store_dwordx4 v4, v[240:243], s[42:43] offset:384
    s_mov_b64 exec, -1
L_skipst_23:
    s_nop 5
    v_cndmask_b32 v96, v96, v100, s[76:77]
    v_cndmask_b32 v97, v97, v101, s[76:77]
    v_cndmask_b32 v98, v98, v102, s[76:77]
    v_cndmask_b32 v99, v99, v103, s[76:77]
    v_perm_b32 v96, v96, s56, v36
    v_perm_b32 v97, v97, s56, v37
    v_perm_b32 v98, v98, s56, v38
    v_perm_b32 v99, v99, s56, v39
    s_mov_b64 exec, s[74:75]
    global_store_dwordx4 v186, v[96:99], s[42:43] offset:1024
    s_mov_b64 exec, -1
    v_mov_b32 v32, 0
    v_mov_b32 v33, 0
    v_mov_b32 v34, 0
    v_mov_b32 v35, 0
    v_perm_b32 v32, v32, s56, v36
    v_perm_b32 v33, v33, s56, v37
    v_perm_b32 v34, v34, s56, v38
    v_perm_b32 v35, v35, s56, v39
    s_lshl_b32 s8, s3, 4
    v_mov_b32 v14, s8
    s_mov_b32 s61, 0
    global_load_dwordx4 v[108:111], v190, s[44:45] offset:384 sc1
    global_load_dwordx4 v[104:107], v191, s[44:45] offset:1024 sc1
L_pollw_24:
    s_waitcnt vmcnt(0)
    v_msad_u8 v128, v108, s57, 0
    v_msad_u8 v128, v109, s58, v128
    v_msad_u8 v128, v110, s59, v128
    v_msad_u8 v128, v111, s60, v128
    v_msad_u8 v128, v104, s57, v128
    v_msad_u8 v128, v105, s58, v128
    v_msad_u8 v128, v106, s59, v128
    v_msad_u8 v128, v107, s60, v128
    v_cmp_ne_u32 vcc, 0, v128
    s_cbranch_vccz L_pollok_26
    s_add_u32 s61, s61, 1
    s_and_b32 s6, s61, 511
    s_cbranch_scc1 L_pollnx_27
    s_call_b64 s[64:65], L_panic
L_pollnx_27:
    s_xor_b32 s44, s44, s50
    s_xor_b32 s45, s45, s51
    global_load_dwordx4 v[108:111], v190, s[44:45] offset:384 sc1
    global_load_dwordx4 v[104:107], v191, s[44:45] offset:1024 sc1
    s_branch L_pollw_24
L_pollok_26:
    v_add_f32_dpp v109, v109, v109 quad_perm:[1,0,3,2] row_mask:0xf bank_mask:0xf
    v_add_f32_dpp v108, v108, v108 quad_perm:[1,0,3,2] row_mask:0xf bank_mask:0xf
s_nop 0
    v_add_f32_dpp v109, v109, v109 quad_perm:[2,3,0,1] row_mask:0xf bank_mask:0xf
    v_add_f32_dpp v108, v108, v108 quad_perm:[2,3,0,1] row_mask:0xf bank_mask:0xf
s_nop 0
    v_add_f32_dpp v109, v109, v109 row_half_mirror row_mask:0xf bank_mask:0xf
    v_add_f32_dpp v108, v108, v108 row_half_mirror row_mask:0xf bank_mask:0xf
    s_mov_b32 s8, 0x3b000000
    v_mul_f32 v109, s8, v109
    v_mul_f32 v108, s8, v108
    v_fma_f32 v108, -v109, v109, v108
    v_max_f32 v108, 0, v108
    v_cvt_pk_bf16_f32 v108, v108, v108
    v_and_b32 v108, 0xffff0000, v108
    v_add_f32 v108, 0x3727c5ac, v108
    v_cvt_pk_bf16_f32 v108, v108, v108
    v_and_b32 v108, 0xffff0000, v108
    v_sqrt_f32 v108, v108
    v_cvt_pk_bf16_f32 v109, v109, v109
    v_and_b32 v109, 0xffff0000, v109
    v_cvt_pk_bf16_f32 v108, v108, v108
    v_and_b32 v108, 0xffff0000, v108
    v_rcp_f32 v108, v108
    v_sub_f32 v109, 0, v109
    v_cndmask_b32 v109, v109, 1.0, s[70:71]
    v_mul_f32 v104, v109, v104
    v_mul_f32 v105, v109, v105
    v_mul_f32 v106, v109, v106
    v_mul_f32 v107, v109, v107
    v_cndmask_b32 v7, v105, v104, s[66:67]
    v_cndmask_b32 v8, v107, v106, s[66:67]
    v_cndmask_b32 v9, v104, v105, s[66:67]
    v_cndmask_b32 v10, v106, v107, s[66:67]
s_nop 0
    v_add_f32_dpp v9, v7, v9 quad_perm:[1,0,3,2] row_mask:0xf bank_mask:0xf
    v_add_f32_dpp v10, v8, v10 quad_perm:[1,0,3,2] row_mask:0xf bank_mask:0xf
    v_cndmask_b32 v7, v10, v9, s[76:77]
    v_cndmask_b32 v8, v9, v10, s[76:77]
s_nop 1
    v_add_f32_dpp v8, v7, v8 quad_perm:[2,3,0,1] row_mask:0xf bank_mask:0xf
s_nop 1
    v_add_f32_dpp v8, v8, v8 row_ror:4 row_mask:0xf bank_mask:0xf
s_nop 1
    v_add_f32_dpp v8, v8, v8 row_ror:8 row_mask:0xf bank_mask:0xf
    v_mul_f32 v8, v108, v8
    v_cvt_pk_bf16_f32 v8, v8, v8
    v_and_b32 v8, 0xffff0000, v8
    v_mov_b32 v7, v8
s_nop 1
    v_permlane16_swap_b32 v8, v7
    s_mov_b32 s8, 0xbfb8aa3b
    v_mul_f32 v9, s8, v8
    v_exp_f32 v9, v9
s_nop 0
    v_add_f32 v9, 1.0, v9
    v_rcp_f32 v9, v9
s_nop 0
    v_mul_f32 v9, v9, v8
    v_cvt_pk_bf16_f32 v9, v9, v9
    v_and_b32 v9, 0xffff0000, v9
    v_mul_f32 v9, v9, v7
    v_cvt_pk_bf16_f32 v9, v9, v9
    s_mov_b32 exec_lo, 15
    s_mov_b32 exec_hi, 15
    ds_write_b16 v192, v9
    s_mov_b64 exec, -1
    s_waitcnt lgkmcnt(0)
    s_barrier
    ds_read_b128 v[60:63], v193
    s_waitcnt lgkmcnt(0)
    v_mfma_f32_16x16x32_bf16 v[96:99], v[224:227], v[60:63], 0
    v_mfma_f32_16x16x32_bf16 v[100:103], v[228:231], v[60:63], 0
    s_mov_b64 exec, 1
    global_store_dwordx4 v14, v[32:35], s[42:43] offset:512
    s_mov_b64 exec, s[0:1]
s_nop 4
    v_cndmask_b32 v96, v96, v100, s[66:67]
    v_cndmask_b32 v97, v97, v101, s[66:67]
    v_cndmask_b32 v98, v98, v102, s[66:67]
    v_cndmask_b32 v99, v99, v103, s[66:67]
    v_perm_b32 v96, v96, s56, v36
    v_perm_b32 v97, v97, s56, v37
    v_perm_b32 v98, v98, s56, v38
    v_perm_b32 v99, v99, s56, v39
    global_store_dwordx4 v194, v[96:99], s[54:55] sc1
    s_mov_b64 exec, -1
    s_cmp_lg_u32 s3, 0
    s_cbranch_scc1 L_stamp_end
    s_mul_i32 s8, s9, 8448
    v_lshrrev_b32 v7, 3, v1
    v_and_b32 v7, 3, v7
    v_lshlrev_b32 v7, 3, v7
    v_bfe_u32 v8, v1, 2, 1
    v_add_u32 v7, v7, v8
    v_mul_u32_u24 v7, 4224, v7
    v_and_b32 v8, 3, v1
    v_lshl_add_u32 v7, v8, 4, v7
    v_add_u32 v7, s8, v7
    s_mov_b32 exec_hi, 0
    s_mov_b32 s61, 0
L_ack:
    global_load_dwordx4 v[104:107], v7, s[40:41] offset:512 sc1
    s_waitcnt vmcnt(0)
    v_msad_u8 v128, v104, s57, 0
    v_msad_u8 v128, v105, s58, v128
    v_msad_u8 v128, v106, s59, v128
    v_msad_u8 v128, v107, s60, v128
    v_cmp_ne_u32 vcc, 0, v128
    s_cbranch_vccz L_stamp_end0
    s_sleep 2
    s_add_u32 s61, s61, 1
    s_cmp_lt_u32 s61, 512
    s_cbranch_scc1 L_ack
    s_call_b64 s[64:65], L_panic
    s_branch L_stamp_end0
L_final:
    s_lshr_b32 s8, s5, 2
    s_lshl_b32 s8, s8, 14
    s_and_b32 s10, s5, 3
    s_lshl_b32 s10, s10, 7
    s_add_u32 s8, s8, s10
    s_lshl_b32 s10, s3, 4
    s_add_u32 s8, s8, s10
    v_lshlrev_b32 v8, 9, v1
    v_add_u32 v8, s8, v8
    v_mov_b32 v104, 0
    v_mov_b32 v105, 0
    v_mov_b32 v106, 0
    v_mov_b32 v107, 0
    v_mov_b32 v108, 0
    v_mov_b32 v109, 0
    v_mov_b32 v110, 0
    v_mov_b32 v111, 0
    s_sleep 40
    s_mov_b32 exec_hi, 0
    s_mov_b32 s61, 0
    global_load_dwordx4 v[104:107], v8, s[52:53] sc1
L_pollw_28:
    s_waitcnt vmcnt(0)
    v_msad_u8 v128, v104, s57, 0
    v_msad_u8 v128, v105, s58, v128
    v_msad_u8 v128, v106, s59, v128
    v_msad_u8 v128, v107, s60, v128
    v_cmp_ne_u32 vcc, 0, v128
    s_cbranch_vccz L_pollok_30
    s_add_u32 s61, s61, 1
    s_and_b32 s6, s61, 511
    s_cbranch_scc1 L_pollnx_31
    s_call_b64 s[64:65], L_panic
L_pollnx_31:
    global_load_dwordx4 v[104:107], v8, s[52:53] sc1
    s_branch L_pollw_28
L_pollok_30:
    s_mov_b64 exec, -1
    v_add_f32_dpp v104, v104, v104 row_ror:1 row_mask:0xf bank_mask:0xf
    v_add_f32_dpp v105, v105, v105 row_ror:1 row_mask:0xf bank_mask:0xf
    v_add_f32_dpp v106, v106, v106 row_ror:1 row_mask:0xf bank_mask:0xf
    v_add_f32_dpp v107, v107, v107 row_ror:1 row_mask:0xf bank_mask:0xf
    v_add_f32_dpp v104, v104, v104 row_ror:2 row_mask:0xf bank_mask:0xf
    v_add_f32_dpp v105, v105, v105 row_ror:2 row_mask:0xf bank_mask:0xf
    v_add_f32_dpp v106, v106, v106 row_ror:2 row_mask:0xf bank_mask:0xf
    v_add_f32_dpp v107, v107, v107 row_ror:2 row_mask:0xf bank_mask:0xf
    v_add_f32_dpp v104, v104, v104 row_ror:4 row_mask:0xf bank_mask:0xf
    v_add_f32_dpp v105, v105, v105 row_ror:4 row_mask:0xf bank_mask:0xf
    v_add_f32_dpp v106, v106, v106 row_ror:4 row_mask:0xf bank_mask:0xf
    v_add_f32_dpp v107, v107, v107 row_ror:4 row_mask:0xf bank_mask:0xf
    v_add_f32_dpp v104, v104, v104 row_ror:8 row_mask:0xf bank_mask:0xf
    v_add_f32_dpp v105, v105, v105 row_ror:8 row_mask:0xf bank_mask:0xf
    v_add_f32_dpp v106, v106, v106 row_ror:8 row_mask:0xf bank_mask:0xf
    v_add_f32_dpp v107, v107, v107 row_ror:8 row_mask:0xf bank_mask:0xf
    v_add_f32_dpp v104, v104, v104 row_bcast:15 row_mask:0xa bank_mask:0xf
    v_add_f32_dpp v105, v105, v105 row_bcast:15 row_mask:0xa bank_mask:0xf
    v_add_f32_dpp v106, v106, v106 row_bcast:15 row_mask:0xa bank_mask:0xf
    v_add_f32_dpp v107, v107, v107 row_bcast:15 row_mask:0xa bank_mask:0xf
    v_add_f32_dpp v104, v104, v104 row_bcast:31 row_mask:0xc bank_mask:0xf
    v_add_f32_dpp v105, v105, v105 row_bcast:31 row_mask:0xc bank_mask:0xf
    v_add_f32_dpp v106, v106, v106 row_bcast:31 row_mask:0xc bank_mask:0xf
    v_add_f32_dpp v107, v107, v107 row_bcast:31 row_mask:0xc bank_mask:0xf
    v_cvt_pk_bf16_f32 v7, v104, v105
    v_lshlrev_b32 v104, 16, v7
    v_and_b32 v105, 0xffff0000, v7
    v_cvt_pk_bf16_f32 v7, v106, v107
    v_lshlrev_b32 v106, 16, v7
    v_and_b32 v107, 0xffff0000, v7
    v_add_f32 v52, v104, v204
    v_add_f32 v53, v105, v205
    v_add_f32 v54, v106, v206
    v_add_f32 v55, v107, v207
    v_cvt_pk_bf16_f32 v7, v52, v53
    v_lshlrev_b32 v52, 16, v7
    v_and_b32 v53, 0xffff0000, v7
    v_cvt_pk_bf16_f32 v7, v54, v55
    v_lshlrev_b32 v54, 16, v7
    v_and_b32 v55, 0xffff0000, v7
    s_mul_i32 s8, s9, 28672
    s_lshl_b32 s10, s7, 6
    s_add_u32 s8, s8, s10
    s_lshl_b32 s10, s3, 4
    s_add_u32 s8, s8, s10
    v_lshlrev_b32 v8, 9, v1
    v_add_u32 v8, s8, v8
    s_lshl_b32 s8, s5, 5
    s_lshl_b32 s10, s3, 3
    s_add_u32 s8, s8, s10
    v_mov_b32 v9, s8
    s_mov_b32 exec_hi, 0x00ffffff
    s_sleep 14
    global_load_dwordx4 v[132:135], v8, s[54:55] sc1
    s_mov_b32 s61, 0
L_h5:
    s_waitcnt vmcnt(0)
    v_msad_u8 v128, v132, s57, 0
    v_msad_u8 v128, v133, s58, v128
    v_msad_u8 v128, v134, s59, v128
    v_msad_u8 v128, v135, s60, v128
    v_cmp_ne_u32 vcc, 0, v128
    s_cbranch_vccz L_h5ok0
    global_load_dwordx4 v[132:135], v8, s[54:55] sc1
    s_add_u32 s61, s61, 1
    s_and_b32 s6, s61, 127
    s_cbranch_scc1 L_h5nx
    s_call_b64 s[64:65], L_panic
L_h5nx:
    s_branch L_h5
L_h5ok0:
    v_mov_b32 v108, v132
    v_mov_b32 v109, v133
    v_mov_b32 v110, v134
    v_mov_b32 v111, v135
L_h5done:
    s_nop 1
    s_mov_b64 exec, -1
    v_add_f32_dpp v108, v108, v108 row_ror:1 row_mask:0xf bank_mask:0xf
    v_add_f32_dpp v109, v109, v109 row_ror:1 row_mask:0xf bank_mask:0xf
    v_add_f32_dpp v110, v110, v110 row_ror:1 row_mask:0xf bank_mask:0xf
    v_add_f32_dpp v111, v111, v111 row_ror:1 row_mask:0xf bank_mask:0xf
    v_add_f32_dpp v108, v108, v108 row_ror:2 row_mask:0xf bank_mask:0xf
    v_add_f32_dpp v109, v109, v109 row_ror:2 row_mask:0xf bank_mask:0xf
    v_add_f32_dpp v110, v110, v110 row_ror:2 row_mask:0xf bank_mask:0xf
    v_add_f32_dpp v111, v111, v111 row_ror:2 row_mask:0xf bank_mask:0xf
    v_add_f32_dpp v108, v108, v108 row_ror:4 row_mask:0xf bank_mask:0xf
    v_add_f32_dpp v109, v109, v109 row_ror:4 row_mask:0xf bank_mask:0xf
    v_add_f32_dpp v110, v110, v110 row_ror:4 row_mask:0xf bank_mask:0xf
    v_add_f32_dpp v111, v111, v111 row_ror:4 row_mask:0xf bank_mask:0xf
    v_add_f32_dpp v108, v108, v108 row_ror:8 row_mask:0xf bank_mask:0xf
    v_add_f32_dpp v109, v109, v109 row_ror:8 row_mask:0xf bank_mask:0xf
    v_add_f32_dpp v110, v110, v110 row_ror:8 row_mask:0xf bank_mask:0xf
    v_add_f32_dpp v111, v111, v111 row_ror:8 row_mask:0xf bank_mask:0xf
    v_add_f32_dpp v108, v108, v108 row_bcast:15 row_mask:0xa bank_mask:0xf
    v_add_f32_dpp v109, v109, v109 row_bcast:15 row_mask:0xa bank_mask:0xf
    v_add_f32_dpp v110, v110, v110 row_bcast:15 row_mask:0xa bank_mask:0xf
    v_add_f32_dpp v111, v111, v111 row_bcast:15 row_mask:0xa bank_mask:0xf
    v_add_f32_dpp v108, v108, v108 row_bcast:31 row_mask:0xc bank_mask:0xf
    v_add_f32_dpp v109, v109, v109 row_bcast:31 row_mask:0xc bank_mask:0xf
    v_add_f32_dpp v110, v110, v110 row_bcast:31 row_mask:0xc bank_mask:0xf
    v_add_f32_dpp v111, v111, v111 row_bcast:31 row_mask:0xc bank_mask:0xf
    v_cvt_pk_bf16_f32 v7, v108, v109
    v_lshlrev_b32 v108, 16, v7
    v_and_b32 v109, 0xffff0000, v7
    v_cvt_pk_bf16_f32 v8, v110, v111
    v_lshlrev_b32 v110, 16, v8
    v_and_b32 v111, 0xffff0000, v8
    v_add_f32 v52, v108, v52
    v_add_f32 v53, v109, v53
    v_add_f32 v54, v110, v54
    v_add_f32 v55, v111, v55
    v_cvt_pk_bf16_f32 v24, v52, v53
    v_cvt_pk_bf16_f32 v25, v54, v55
    s_mov_b32 exec_lo, 0
    s_mov_b32 exec_hi, 0x80000000
    global_store_dwordx2 v9, v[24:25], s[34:35]
    s_or_b32 s8, s5, s3
    s_cmp_lg_u32 s8, 0
    s_cbranch_scc1 L_stamp_end0
    v_mov_b32 v7, 0
    v_mov_b32 v8, s13
    global_store_dword v7, v8, s[38:39]
L_stamp_end0:
    s_mov_b64 exec, -1
L_stamp_end:
    s_endpgm
L_loader7:
    s_waitcnt vmcnt(15)
    s_add_u32 s13, s12, 0
    s_and_b32 s13, s13, 7
    s_lshl_b32 s6, s13, 12
    s_add_u32 m0, s6, 0
    s_lshl_b32 s6, s13, 17
    s_add_u32 s60, s40, s6
    s_addc_u32 s61, s41, 0
    global_load_lds_dwordx4 v104, s[60:61] offset:0 nt
    s_waitcnt vmcnt(15)
    global_load_lds_dwordx4 v105, s[60:61] offset:1024 nt
    s_waitcnt vmcnt(15)
    global_load_lds_dwordx4 v106, s[60:61] offset:2048 nt
    s_waitcnt vmcnt(15)
    global_load_lds_dwordx4 v107, s[60:61] offset:3072 nt
    s_waitcnt vmcnt(15)
    s_add_u32 s13, s12, 1
    s_and_b32 s13, s13, 7
    s_lshl_b32 s6, s13, 12
    s_add_u32 m0, s6, 0
    s_lshl_b32 s6, s13, 17
    s_add_u32 s60, s40, s6
    s_addc_u32 s61, s41, 0
    global_load_lds_dwordx4 v104, s[60:61] offset:0 nt
    s_waitcnt vmcnt(15)
    global_load_lds_dwordx4 v105, s[60:61] offset:1024 nt
    s_waitcnt vmcnt(15)
    global_load_lds_dwordx4 v106, s[60:61] offset:2048 nt
    s_waitcnt vmcnt(15)
    global_load_lds_dwordx4 v107, s[60:61] offset:3072 nt
    s_waitcnt vmcnt(15)
    s_add_u32 s13, s12, 2
    s_and_b32 s13, s13, 7
    s_lshl_b32 s6, s13, 12
    s_add_u32 m0, s6, 0
    s_lshl_b32 s6, s13, 17
    s_add_u32 s60, s40, s6
    s_addc_u32 s61, s41, 0
    global_load_lds_dwordx4 v104, s[60:61] offset:0 nt
    s_waitcnt vmcnt(15)
    global_load_lds_dwordx4 v105, s[60:61] offset:1024 nt
    s_waitcnt vmcnt(15)
    global_load_lds_dwordx4 v106, s[60:61] offset:2048 nt
    s_waitcnt vmcnt(15)
    global_load_lds_dwordx4 v107, s[60:61] offset:3072 nt
    s_waitcnt vmcnt(15)
    s_add_u32 s13, s12, 3
    s_and_b32 s13, s13, 7
    s_lshl_b32 s6, s13, 12
    s_add_u32 m0, s6, 0
    s_lshl_b32 s6, s13, 17
    s_add_u32 s60, s40, s6
    s_addc_u32 s61, s41, 0
    global_load_lds_dwordx4 v104, s[60:61] offset:0 nt
    s_waitcnt vmcnt(15)
    global_load_lds_dwordx4 v105, s[60:61] offset:1024 nt
    s_waitcnt vmcnt(15)
    global_load_lds_dwordx4 v106, s[60:61] offset:2048 nt
    s_waitcnt vmcnt(15)
    s_mov_b64 exec, 1
    ds_add_u32 v5, v6 offset:0
    s_mov_b64 exec, -1
    global_load_lds_dwordx4 v107, s[60:61] offset:3072 nt
    s_waitcnt vmcnt(15)
    s_add_u32 s13, s12, 4
    s_and_b32 s13, s13, 7
    s_lshl_b32 s6, s13, 12
    s_add_u32 m0, s6, 0
    s_lshl_b32 s6, s13, 17
    s_add_u32 s60, s40, s6
    s_addc_u32 s61, s41, 0
    global_load_lds_dwordx4 v104, s[60:61] offset:0 nt
    s_waitcnt vmcnt(15)
    global_load_lds_dwordx4 v105, s[60:61] offset:1024 nt
    s_waitcnt vmcnt(15)
    global_load_lds_dwordx4 v106, s[60:61] offset:2048 nt
    s_waitcnt vmcnt(15)
    global_load_lds_dwordx4 v107, s[60:61] offset:3072 nt
    s_waitcnt vmcnt(15)
    s_add_u32 s13, s12, 5
    s_and_b32 s13, s13, 7
    s_lshl_b32 s6, s13, 12
    s_add_u32 m0, s6, 0
    s_lshl_b32 s6, s13, 17
    s_add_u32 s60, s40, s6
    s_addc_u32 s61, s41, 0
    global_load_lds_dwordx4 v104, s[60:61] offset:0 nt
    s_waitcnt vmcnt(15)
    global_load_lds_dwordx4 v105, s[60:61] offset:1024 nt
    s_waitcnt vmcnt(15)
    global_load_lds_dwordx4 v106, s[60:61] offset:2048 nt
    s_waitcnt vmcnt(15)
    global_load_lds_dwordx4 v107, s[60:61] offset:3072 nt
    s_waitcnt vmcnt(15)
    s_add_u32 s13, s12, 6
    s_and_b32 s13, s13, 7
    s_lshl_b32 s6, s13, 12
    s_add_u32 m0, s6, 0
    s_lshl_b32 s6, s13, 17
    s_add_u32 s60, s40, s6
    s_addc_u32 s61, s41, 0
    global_load_lds_dwordx4 v104, s[60:61] offset:0 nt
    s_waitcnt vmcnt(15)
    global_load_lds_dwordx4 v105, s[60:61] offset:1024 nt
    s_waitcnt vmcnt(15)
    global_load_lds_dwordx4 v106, s[60:61] offset:2048 nt
    s_waitcnt vmcnt(15)
    global_load_lds_dwordx4 v107, s[60:61] offset:3072 nt
    s_waitcnt vmcnt(15)
    s_add_u32 s13, s12, 7
    s_and_b32 s13, s13, 7
    s_lshl_b32 s6, s13, 12
    s_add_u32 m0, s6, 0
    s_lshl_b32 s6, s13, 17
    s_add_u32 s60, s40, s6
    s_addc_u32 s61, s41, 0
    global_load_lds_dwordx4 v104, s[60:61] offset:0 nt
    s_waitcnt vmcnt(15)
    global_load_lds_dwordx4 v105, s[60:61] offset:1024 nt
    s_waitcnt vmcnt(15)
    global_load_lds_dwordx4 v106, s[60:61] offset:2048 nt
    s_waitcnt vmcnt(15)
    global_load_lds_dwordx4 v107, s[60:61] offset:3072 nt
    s_waitcnt vmcnt(31)
    s_add_u32 s13, s12, 0
    s_and_b32 s13, s13, 7
    s_lshl_b32 s6, s13, 12
    s_add_u32 m0, s6, 32768
    s_lshl_b32 s6, s13, 17
    s_add_u32 s60, s42, s6
    s_addc_u32 s61, s43, 0
    global_load_lds_dwordx4 v108, s[60:61] offset:0 nt
    s_waitcnt vmcnt(31)
    global_load_lds_dwordx4 v109, s[60:61] offset:1024 nt
    s_waitcnt vmcnt(31)
    global_load_lds_dwordx4 v115, s[60:61] offset:2048 nt
    s_waitcnt vmcnt(31)
    global_load_lds_dwordx4 v127, s[60:61] offset:3072 nt
    s_waitcnt vmcnt(31)
    s_add_u32 s13, s12, 1
    s_and_b32 s13, s13, 7
    s_lshl_b32 s6, s13, 12
    s_add_u32 m0, s6, 32768
    s_lshl_b32 s6, s13, 17
    s_add_u32 s60, s42, s6
    s_addc_u32 s61, s43, 0
    global_load_lds_dwordx4 v108, s[60:61] offset:0 nt
    s_waitcnt vmcnt(31)
    global_load_lds_dwordx4 v109, s[60:61] offset:1024 nt
    s_waitcnt vmcnt(31)
    global_load_lds_dwordx4 v115, s[60:61] offset:2048 nt
    s_waitcnt vmcnt(31)
    global_load_lds_dwordx4 v127, s[60:61] offset:3072 nt
    s_waitcnt vmcnt(31)
    s_add_u32 s13, s12, 2
    s_and_b32 s13, s13, 7
    s_lshl_b32 s6, s13, 12
    s_add_u32 m0, s6, 32768
    s_lshl_b32 s6, s13, 17
    s_add_u32 s60, s42, s6
    s_addc_u32 s61, s43, 0
    global_load_lds_dwordx4 v108, s[60:61] offset:0 nt
    s_waitcnt vmcnt(31)
    global_load_lds_dwordx4 v109, s[60:61] offset:1024 nt
    s_waitcnt vmcnt(31)
    global_load_lds_dwordx4 v115, s[60:61] offset:2048 nt
    s_waitcnt vmcnt(31)
    global_load_lds_dwordx4 v127, s[60:61] offset:3072 nt
    s_waitcnt vmcnt(31)
    s_add_u32 s13, s12, 3
    s_and_b32 s13, s13, 7
    s_lshl_b32 s6, s13, 12
    s_add_u32 m0, s6, 32768
    s_lshl_b32 s6, s13, 17
    s_add_u32 s60, s42, s6
    s_addc_u32 s61, s43, 0
    global_load_lds_dwordx4 v108, s[60:61] offset:0 nt
    s_waitcnt vmcnt(31)
    global_load_lds_dwordx4 v109, s[60:61] offset:1024 nt
    s_waitcnt vmcnt(31)
    global_load_lds_dwordx4 v115, s[60:61] offset:2048 nt
    s_waitcnt vmcnt(31)
    global_load_lds_dwordx4 v127, s[60:61] offset:3072 nt
    s_waitcnt vmcnt(31)
    s_add_u32 s13, s12, 4
    s_and_b32 s13, s13, 7
    s_lshl_b32 s6, s13, 12
    s_add_u32 m0, s6, 32768
    s_lshl_b32 s6, s13, 17
    s_add_u32 s60, s42, s6
    s_addc_u32 s61, s43, 0
    global_load_lds_dwordx4 v108, s[60:61] offset:0 nt
    s_waitcnt vmcnt(31)
    global_load_lds_dwordx4 v109, s[60:61] offset:1024 nt
    s_waitcnt vmcnt(31)
    global_load_lds_dwordx4 v115, s[60:61] offset:2048 nt
    s_waitcnt vmcnt(31)
    global_load_lds_dwordx4 v127, s[60:61] offset:3072 nt
    s_waitcnt vmcnt(31)
    s_add_u32 s13, s12, 5
    s_and_b32 s13, s13, 7
    s_lshl_b32 s6, s13, 12
    s_add_u32 m0, s6, 32768
    s_lshl_b32 s6, s13, 17
    s_add_u32 s60, s42, s6
    s_addc_u32 s61, s43, 0
    global_load_lds_dwordx4 v108, s[60:61] offset:0 nt
    s_waitcnt vmcnt(31)
    global_load_lds_dwordx4 v109, s[60:61] offset:1024 nt
    s_waitcnt vmcnt(31)
    global_load_lds_dwordx4 v115, s[60:61] offset:2048 nt
    s_waitcnt vmcnt(31)
    global_load_lds_dwordx4 v127, s[60:61] offset:3072 nt
    s_waitcnt vmcnt(31)
    s_add_u32 s13, s12, 6
    s_and_b32 s13, s13, 7
    s_lshl_b32 s6, s13, 12
    s_add_u32 m0, s6, 32768
    s_lshl_b32 s6, s13, 17
    s_add_u32 s60, s42, s6
    s_addc_u32 s61, s43, 0
    global_load_lds_dwordx4 v108, s[60:61] offset:0 nt
    s_waitcnt vmcnt(31)
    global_load_lds_dwordx4 v109, s[60:61] offset:1024 nt
    s_waitcnt vmcnt(31)
    global_load_lds_dwordx4 v115, s[60:61] offset:2048 nt
    s_waitcnt vmcnt(31)
    global_load_lds_dwordx4 v127, s[60:61] offset:3072 nt
    s_waitcnt vmcnt(31)
    s_add_u32 s13, s12, 7
    s_and_b32 s13, s13, 7
    s_lshl_b32 s6, s13, 12
    s_add_u32 m0, s6, 32768
    s_lshl_b32 s6, s13, 17
    s_add_u32 s60, s42, s6
    s_addc_u32 s61, s43, 0
    global_load_lds_dwordx4 v108, s[60:61] offset:0 nt
    s_waitcnt vmcnt(31)
    global_load_lds_dwordx4 v109, s[60:61] offset:1024 nt
    s_waitcnt vmcnt(31)
    global_load_lds_dwordx4 v115, s[60:61] offset:2048 nt
    s_waitcnt vmcnt(31)
    s_mov_b64 exec, 1
    ds_add_u32 v5, v6 offset:24
    s_mov_b64 exec, -1
    global_load_lds_dwordx4 v127, s[60:61] offset:3072 nt
    s_waitcnt vmcnt(31)
    s_mov_b32 m0, 81920
s_nop 0
    global_load_lds_dwordx4 v111, s[44:45] nt
    s_waitcnt vmcnt(31)
    s_mov_b32 m0, 82944
    s_add_u32 s44, s44, 8192
    s_addc_u32 s45, s45, 0
    global_load_lds_dwordx4 v111, s[44:45] nt
    s_waitcnt vmcnt(31)
    s_mov_b32 m0, 83968
    s_add_u32 s44, s44, 8192
    s_addc_u32 s45, s45, 0
    global_load_lds_dwordx4 v111, s[44:45] nt
    s_waitcnt vmcnt(31)
    s_mov_b32 m0, 84992
    s_add_u32 s44, s44, 8192
    s_addc_u32 s45, s45, 0
    global_load_lds_dwordx4 v111, s[44:45] nt
    s_waitcnt vmcnt(31)
    s_mov_b32 m0, 86016
    s_add_u32 s44, s44, 8192
    s_addc_u32 s45, s45, 0
    global_load_lds_dwordx4 v111, s[44:45] nt
    s_waitcnt vmcnt(31)
    s_mov_b32 m0, 87040
    s_add_u32 s44, s44, 8192
    s_addc_u32 s45, s45, 0
    global_load_lds_dwordx4 v111, s[44:45] nt
    s_waitcnt vmcnt(31)
    s_mov_b32 m0, 88064
    s_add_u32 s44, s44, 8192
    s_addc_u32 s45, s45, 0
    global_load_lds_dwordx4 v111, s[44:45] nt
    s_waitcnt vmcnt(31)
    s_mov_b32 m0, 89088
    s_add_u32 s44, s44, 8192
    s_addc_u32 s45, s45, 0
    global_load_lds_dwordx4 v111, s[44:45] nt
    s_waitcnt vmcnt(31)
    s_mov_b32 m0, 90112
    s_add_u32 s44, s44, 8192
    s_addc_u32 s45, s45, 0
    global_load_lds_dwordx4 v111, s[44:45] nt
    s_waitcnt vmcnt(31)
    s_mov_b32 m0, 91136
    s_add_u32 s44, s44, 8192
    s_addc_u32 s45, s45, 0
    global_load_lds_dwordx4 v111, s[44:45] nt
    s_waitcnt vmcnt(31)
    s_mov_b32 m0, 92160
    s_add_u32 s44, s44, 8192
    s_addc_u32 s45, s45, 0
    global_load_lds_dwordx4 v111, s[44:45] nt
    s_waitcnt vmcnt(31)
    s_mov_b32 m0, 93184
    s_add_u32 s44, s44, 8192
    s_addc_u32 s45, s45, 0
    global_load_lds_dwordx4 v111, s[44:45] nt
    s_waitcnt vmcnt(31)
    s_mov_b32 m0, 94208
    s_add_u32 s44, s44, 8192
    s_addc_u32 s45, s45, 0
    global_load_lds_dwordx4 v111, s[44:45] nt
    s_waitcnt vmcnt(31)
    s_mov_b32 m0, 95232
    s_add_u32 s44, s44, 8192
    s_addc_u32 s45, s45, 0
    global_load_lds_dwordx4 v111, s[44:45] nt
    s_waitcnt vmcnt(31)
    s_mov_b32 m0, 96256
    s_add_u32 s44, s44, 8192
    s_addc_u32 s45, s45, 0
    global_load_lds_dwordx4 v111, s[44:45] nt
    s_waitcnt vmcnt(31)
    s_mov_b32 m0, 97280
    s_add_u32 s44, s44, 8192
    s_addc_u32 s45, s45, 0
    global_load_lds_dwordx4 v111, s[44:45] nt
    s_waitcnt vmcnt(16)
    s_mov_b64 exec, 1
    ds_add_u32 v5, v6 offset:28
    s_mov_b64 exec, -1
    s_waitcnt vmcnt(0)
    s_mov_b64 exec, 1
    ds_add_u32 v5, v6 offset:32
    s_mov_b64 exec, -1
L_end:
    s_endpgm
L_panic:
    s_mov_b64 s[100:101], exec
    s_mov_b64 exec, -1
    global_load_dwordx4 v[20:23], v4, s[42:43] offset:0 sc1
    s_waitcnt vmcnt(0)
    global_store_dwordx4 v4, v[20:23], s[48:49] offset:0 sc1
    s_waitcnt vmcnt(0)
    global_load_dwordx4 v[20:23], v4, s[42:43] offset:1024 sc1
    s_waitcnt vmcnt(0)
    global_store_dwordx4 v4, v[20:23], s[48:49] offset:1024 sc1
    s_waitcnt vmcnt(0)
    global_load_dwordx4 v[20:23], v4, s[42:43] offset:2048 sc1
    s_waitcnt vmcnt(0)
    global_store_dwordx4 v4, v[20:23], s[48:49] offset:2048 sc1
    s_waitcnt vmcnt(0)
    global_load_dwordx4 v[20:23], v4, s[42:43] offset:3072 sc1
    s_waitcnt vmcnt(0)
    global_store_dwordx4 v4, v[20:23], s[48:49] offset:3072 sc1
    s_waitcnt vmcnt(0)
    s_xor_b32 s50, s40, s46
    s_xor_b32 s51, s41, s47
    s_add_u32 s62, s62, 1
    s_cmp_ge_u32 s62, 4000
    s_cbranch_scc1 L_end
    s_mov_b64 exec, s[100:101]
    s_setpc_b64 s[64:65]
    .fill ((sequential_preLN__sliding_block_cached__glu_gated_swiglu__decode_kernel + 17664 - .) >> 2) * (((sequential_preLN__sliding_block_cached__glu_gated_swiglu__decode_kernel + 17664 - .) >> 63) + 1), 4, 0xbf810000
.section .rodata,"a"
.p2align 6
.amdhsa_kernel sequential_preLN__sliding_block_cached__glu_gated_swiglu__decode_kernel
  .amdhsa_next_free_vgpr 248
  .amdhsa_next_free_sgpr 102
  .amdhsa_accum_offset 248
  .amdhsa_group_segment_fixed_size 0
  .amdhsa_kernarg_size 96
  .amdhsa_user_sgpr_count 2
  .amdhsa_user_sgpr_kernarg_segment_ptr 1
  .amdhsa_system_sgpr_workgroup_id_x 1
.end_amdhsa_kernel
```
